```python
import torch

def _softmax(x, axis=-1):
    return torch.softmax(x, dim=axis)
def _gelu(x):
    return torch.nn.functional.gelu(x, approximate="tanh")
def _silu(x):
    return torch.nn.functional.silu(x)
def _sigmoid(x):
    return torch.sigmoid(x)
def _layernorm(x, axis=-1, eps=1e-5):
    m = x.mean(dim=axis, keepdim=True)
    v = x.var(dim=axis, keepdim=True, unbiased=False)
    return (x - m) / torch.sqrt(v + eps)
def _scatter_add(tgt, idx, src, axis=0):
    return tgt.clone().index_add_(axis, idx, src)
def _segment_sum(src, seg, n):
    out = torch.zeros((n,) + src.shape[1:], dtype=src.dtype)
    return out.index_add_(0, seg, src)
def _pad(x, pw):
    flat = tuple(v for pair in reversed(pw) for v in pair)
    return torch.nn.functional.pad(x, flat)

kernel_name = 'gated_mix__ssm_conv_s5__swiglu_ffn__prompt'

def setup_inputs():

    _w = (lambda a: (lambda t: t.to(torch.bfloat16) if t.is_floating_point() else t)(torch.as_tensor(a)))
    def _A_setup():
        B, S, D = 1, 2048, 512
        P = D
        Lambda_re = -0.5 * (lambda _x: torch.exp(torch.as_tensor(_x)))((lambda *s: torch.randn(*s, dtype=torch.bfloat16) * 0.2)(P))
        Lambda_im = (lambda *s: torch.randn(*s, dtype=torch.bfloat16) * 0.4)(P) * 1.0
        B_re = (lambda *s: torch.randn(*s, dtype=torch.bfloat16) * 0.2)(P, D) * (D ** -0.5)
        B_im = (lambda *s: torch.randn(*s, dtype=torch.bfloat16) * 0.2)(P, D) * (D ** -0.5)
        C_re = (lambda *s: torch.randn(*s, dtype=torch.bfloat16) * 0.2)(D, P) * (P ** -0.5)
        C_im = (lambda *s: torch.randn(*s, dtype=torch.bfloat16) * 0.2)(D, P) * (P ** -0.5)
        log_dt = (lambda *s: torch.randn(*s, dtype=torch.bfloat16) * 0.2)(P) * 0.3 - 2.0
        Dskip = (lambda *s: torch.randn(*s, dtype=torch.bfloat16) * 0.05)(D)
        return {
            "x": _w((lambda *s: torch.randn(*s, dtype=torch.bfloat16) * 0.05)(B, S, D)),
            "Lambda_re": _w(Lambda_re),
            "Lambda_im": _w(Lambda_im),
            "B_re": _w(B_re),
            "B_im": _w(B_im),
            "C_re": _w(C_re),
            "C_im": _w(C_im),
            "log_dt": _w(log_dt),
            "Dskip": _w(Dskip),
        }
    _A_in = _A_setup()

    def _B_setup():
        B, S, D, F = 1, 2048, 512, 1376
        return {
            "x": _w((lambda *s: torch.randn(*s, dtype=torch.bfloat16) * 0.05)(B, S, D)),
            "w_gate": _w((lambda *s: torch.randn(*s, dtype=torch.bfloat16) * 0.05)(D, F)),
            "w_up": _w((lambda *s: torch.randn(*s, dtype=torch.bfloat16) * 0.05)(D, F)),
            "w_down": _w((lambda *s: torch.randn(*s, dtype=torch.bfloat16) * 0.05)(F, D)),
        }
    _B_in = _B_setup()

    return {
        "A_x": _A_in["x"],
        "A_Lambda_re": _A_in["Lambda_re"],
        "A_Lambda_im": _A_in["Lambda_im"],
        "A_B_re": _A_in["B_re"],
        "A_B_im": _A_in["B_im"],
        "A_C_re": _A_in["C_re"],
        "A_C_im": _A_in["C_im"],
        "A_log_dt": _A_in["log_dt"],
        "A_Dskip": _A_in["Dskip"],
        "B_x": _B_in["x"],
        "B_w_gate": _B_in["w_gate"],
        "B_w_up": _B_in["w_up"],
        "B_w_down": _B_in["w_down"],
        "gate_w": _w((lambda *s: torch.randn(*s, dtype=torch.bfloat16) * 0.05)(512) * 16.0),
    }

def reference(A_x, A_Lambda_re, A_Lambda_im, A_B_re, A_B_im, A_C_re, A_C_im, A_log_dt, A_Dskip, B_x, B_w_gate, B_w_up, B_w_down, gate_w):
    def _A_ref(x, Lambda_re, Lambda_im, B_re, B_im, C_re, C_im, log_dt, Dskip):
        Bsz, L, H = x.shape
        Lam = Lambda_re + 1j * Lambda_im
        Bmat = B_re + 1j * B_im
        Cmat = C_re + 1j * C_im
        dt = torch.exp(log_dt)
        Lam_bar = torch.exp(dt * Lam)
        B_bar = ((Lam_bar - 1.0) / Lam)[:, None] * Bmat
        Bu = torch.einsum("bld,pd->blp", x + 0j, B_bar)
        h = torch.zeros_like(Bu[:, 0, :])
        hs = []
        for t in range(L):
            h = Lam_bar[None, :] * h + Bu[:, t, :]
            hs.append(h)
        hseq = torch.stack(hs, 1)
        y = 2.0 * torch.einsum("blp,dp->bld", hseq, Cmat).real + x * Dskip[None, None, :]
        return y

    def _B_ref(x, w_gate, w_up, w_down):
        g = _silu(x @ w_gate)
        u = x @ w_up
        return (g * u) @ w_down

    x = A_x
    g = _sigmoid((x * gate_w).sum(-1, keepdims=True))
    a = _A_ref(x, A_Lambda_re, A_Lambda_im, A_B_re, A_B_im, A_C_re, A_C_im, A_log_dt, A_Dskip)
    b = _B_ref(x, B_w_gate, B_w_up, B_w_down)
    return g * a + (1 - g) * b
```

```asm
; @launch grid=(256,1,1) block=(512,1,1) lds=163840
.amdgcn_target "amdgcn-amd-amdhsa--gfx950"
.text
.globl gated_mix__ssm_conv_s5__swiglu_ffn__prompt_kernel
.p2align 8
.type gated_mix__ssm_conv_s5__swiglu_ffn__prompt_kernel,@function
gated_mix__ssm_conv_s5__swiglu_ffn__prompt_kernel:
    s_load_dwordx16 s[4:19], s[0:1], 0
    s_cmp_ge_u32 s2, 256
    s_cbranch_scc1 L_end
    s_load_dwordx16 s[20:35], s[0:1], 64
    s_load_dwordx2 s[36:37], s[0:1], 128
    s_getpc_b64 s[60:61]
L_pc:
    s_mov_b32 s62, L_end-L_pc
    s_mov_b32 s63, 0x20000
    s_lshl_b32 s73, s2, 9
    s_and_b32 s73, s73, 0x7000
    v_lshlrev_b32 v1, 3, v0
    s_mov_b32 exec_lo, 0x10001
    s_mov_b32 exec_hi, 0x10001
    buffer_load_dword v63, v1, s[60:63], s73 offen
    s_mov_b64 exec, -1
    v_lshrrev_b32 v1, 6, v0
    v_and_b32 v0, 63, v0
    v_readfirstlane_b32 s64, v1
    s_and_b32 s73, s2, 7
    s_bfe_u32 s75, s2, 0x30003
    s_lshr_b32 s76, s2, 6
    s_lshl1_add_u32 s68, s75, s73
    s_lshl2_add_u32 s68, s76, s68
    s_and_b32 s68, s68, 7
    s_and_b32 s66, s2, 1
    s_lshl3_add_u32 s66, s66, s75
    s_lshr_b32 s77, s73, 1
    s_lshl2_add_u32 s67, s77, s76
    s_and_b32 s65, s64, 3
    s_cmp_lt_u32 s64, 4
    s_cbranch_scc1 L_A
    v_lshrrev_b32 v8, 3, v0
    v_and_b32 v9, 7, v0
    v_lshrrev_b32 v10, 4, v0
    v_xor_b32 v10, v9, v10
    v_lshlrev_b32 v10, 4, v10
    v_lshrrev_b32 v11, 5, v0
    v_and_b32 v12, 3, v8
    v_lshl_add_u32 v11, v11, 4, v12
    s_lshl2_add_u32 s73, s66, s65
    s_lshl_b32 s73, s73, 15
    v_lshl_add_u32 v11, v11, 10, s73
    s_lshl_b32 s62, s65, 6
    s_and_b32 s62, s62, 64
    v_xad_u32 v32, v10, s62, v11
    v_xor_b32 v13, 64, v32
    v_add_u32 v33, 3072, v13
    v_add_u32 v34, 6144, v32
    v_add_u32 v35, 9216, v13
    s_lshl_b32 s60, s65, 12
    s_lshl_b32 s79, s68, 7
    s_mov_b32 s42, 0x200000
    s_mov_b32 s43, 0x20000
    s_add_u32 m0, s60, 98304
    s_mov_b32 s98, s79
    s_waitcnt lgkmcnt(0)
    s_mov_b64 s[40:41], s[4:5]
    buffer_load_dwordx4 v32, s[40:43], s98 offen offset:0 lds
    buffer_load_dwordx4 v33, s[40:43], s98 offen offset:1024 lds
    buffer_load_dwordx4 v34, s[40:43], s98 offen offset:2048 lds
    buffer_load_dwordx4 v35, s[40:43], s98 offen offset:3072 lds
    s_and_b32 s74, s65, 1
    s_lshl1_add_u32 s73, s67, s74
    s_lshl_b32 s73, s73, 14
    v_lshrrev_b32 v11, 5, v0
    v_lshl_add_u32 v11, v11, 3, v12
    v_lshl_add_u32 v11, v11, 10, s73
    v_add_u32 v36, v11, v10
    v_xor_b32 v13, 64, v36
    v_add_u32 v37, 3072, v13
    s_lshl_b32 s61, s65, 11
    s_add_u32 s61, s61, 16384
    s_mov_b32 s50, 0x80000
    s_mov_b32 s51, 0x20000
    s_add_u32 m0, s61, 98304
    s_cmp_ge_u32 s65, 2
    s_cselect_b64 s[48:49], s[12:13], s[10:11]
    buffer_load_dwordx4 v36, s[48:51], s98 offen offset:0 lds
    buffer_load_dwordx4 v37, s[48:51], s98 offen offset:1024 lds
    s_add_u32 m0, s60, 122880
    s_add_u32 s98, s79, 128
    s_and_b32 s98, s98, 1023
    buffer_load_dwordx4 v32, s[40:43], s98 offen offset:0 lds
    buffer_load_dwordx4 v33, s[40:43], s98 offen offset:1024 lds
    v_lshrrev_b32 v11, 4, v0
    v_bfe_u32 v12, v0, 1, 3
    v_xor_b32 v11, v11, v12
    v_and_b32 v12, 15, v0
    v_lshlrev_b32 v12, 7, v12
    v_lshl_add_u32 v44, v11, 4, v12
    v_xor_b32 v45, 64, v44
    v_xor_b32 v44, s62, v44
    v_add_u32 v44, s60, v44
    v_add_u32 v46, 49152, v44
    v_add_u32 v48, 98304, v44
    v_xor_b32 v45, s62, v45
    v_add_u32 v45, s60, v45
    v_add_u32 v47, 49152, v45
    v_add_u32 v49, 98304, v45
    v_lshlrev_b32 v11, 2, v0
    v_add_u32 v11, 151552, v11
    v_mov_b32 v12, 0
    ds_write_b32 v11, v12
    buffer_load_dwordx4 v34, s[40:43], s98 offen offset:2048 lds
    buffer_load_dwordx4 v35, s[40:43], s98 offen offset:3072 lds
    s_add_u32 m0, s61, 122880
    s_nop 0
    buffer_load_dwordx4 v36, s[48:51], s98 offen offset:0 lds
    buffer_load_dwordx4 v37, s[48:51], s98 offen offset:1024 lds
    s_add_u32 m0, s60, 0
    s_add_u32 s98, s79, 256
    s_and_b32 s98, s98, 1023
    buffer_load_dwordx4 v32, s[40:43], s98 offen offset:0 lds
    buffer_load_dwordx4 v33, s[40:43], s98 offen offset:1024 lds
    s_waitcnt vmcnt(8)
    s_barrier
    buffer_load_dwordx4 v34, s[40:43], s98 offen offset:2048 lds
    buffer_load_dwordx4 v35, s[40:43], s98 offen offset:3072 lds
    s_add_u32 m0, s61, 0
    s_nop 0
    buffer_load_dwordx4 v36, s[48:51], s98 offen offset:0 lds
    buffer_load_dwordx4 v37, s[48:51], s98 offen offset:1024 lds
    s_add_u32 m0, s60, 24576
    s_add_u32 s98, s79, 384
    s_and_b32 s98, s98, 1023
    buffer_load_dwordx4 v32, s[40:43], s98 offen offset:0 lds
    buffer_load_dwordx4 v33, s[40:43], s98 offen offset:1024 lds
    ds_read_b128 v[128:131], v48 offset:0
    ds_read_b128 v[132:135], v48 offset:2048
    ds_read_b128 v[136:139], v49 offset:0
    ds_read_b128 v[140:143], v49 offset:2048
    s_and_b32 s73, s2, 7
    s_lshr_b32 s74, s2, 3
    s_and_b32 s75, s74, 7
    s_lshr_b32 s76, s74, 3
    s_lshr_b32 s77, s73, 1
    s_mul_i32 s72, s77, 11
    s_mul_i32 s78, s76, 3
    s_add_u32 s72, s72, s78
    s_cmp_eq_u32 s67, 15
    s_subb_u32 s72, s72, 0
    s_lshl_b32 s69, s77, 3
    s_add_u32 s69, s69, s75
    s_and_b32 s70, s73, 1
    s_lshl_b32 s70, s70, 2
    s_add_u32 s70, s70, s76
    s_mov_b32 s44, s36
    s_mov_b32 s45, s37
    s_mov_b32 s46, 0xb80000
    s_mov_b32 s47, 0x20000
    s_mov_b32 s56, s28
    s_mov_b32 s57, s29
    s_mov_b32 s58, 0x158000
    s_mov_b32 s59, 0x20000
    s_cmp_ge_u32 s65, 2
    s_cselect_b32 s52, s26, s24
    s_cselect_b32 s53, s27, s25
    s_mov_b32 s54, 0x158000
    s_mov_b32 s55, 0x20000
    v_lshrrev_b32 v13, 4, v0
    v_bfe_u32 v14, v0, 2, 2
    v_lshl_add_u32 v13, v13, 3, v14
    v_mul_u32_u24 v13, 192, v13
    v_bfe_u32 v14, v0, 4, 1
    v_lshl_add_u32 v13, v14, 5, v13
    v_and_b32 v14, 3, v0
    v_lshl_add_u32 v2, v14, 3, v13
    v_xor_b32 v3, 32, v2
    v_add_u32 v4, 49152, v2
    v_add_u32 v5, 49152, v3
    v_lshlrev_b32 v1, 4, v0
    s_waitcnt vmcnt(8) lgkmcnt(0)
    s_barrier
    s_mov_b32 s73, 0xb48000
    buffer_load_dword v42, off, s[44:47], s73 sc1
    buffer_load_dwordx4 v34, s[40:43], s98 offen offset:2048 lds
    buffer_load_dwordx4 v35, s[40:43], s98 offen offset:3072 lds
    s_add_u32 m0, s61, 24576
    s_nop 0
    buffer_load_dwordx4 v36, s[48:51], s98 offen offset:0 lds
    buffer_load_dwordx4 v37, s[48:51], s98 offen offset:1024 lds
    s_add_u32 m0, s60, 49152
    s_add_u32 s98, s79, 512
    s_and_b32 s98, s98, 1023
    buffer_load_dwordx4 v32, s[40:43], s98 offen offset:0 lds
    buffer_load_dwordx4 v33, s[40:43], s98 offen offset:1024 lds
    ds_read_b128 v[144:147], v48 offset:24576
    ds_read_b128 v[148:151], v48 offset:26624
    ds_read_b128 v[152:155], v49 offset:24576
    ds_read_b128 v[156:159], v49 offset:26624
    s_and_b32 s73, s67, 3
    s_cmp_eq_u32 s73, 3
    s_cselect_b32 s73, 14, s67
    s_cmp_eq_u32 s73, 14
    s_cselect_b32 s99, 8, 12
    s_and_b32 s74, s65, 1
    s_mul_i32 s73, s74, 88064
    s_lshl_b32 s74, s72, 6
    s_add_u32 s73, s73, s74
    v_add_u32 v14, 0, v0
    v_mul_u32_u24 v13, 171, v14
    v_lshrrev_b32 v13, 11, v13
    v_mul_u32_u24 v38, 12, v13
    v_sub_u32 v14, v14, v38
    v_cmp_gt_u32 vcc, s99, v14
    v_lshrrev_b32 v14, 3, v13
    v_lshlrev_b32 v14, 1, v14
    v_xor_b32 v14, v0, v14
    v_mul_u32_u24 v13, 2560, v13
    v_lshl_add_u32 v13, v14, 4, v13
    v_add_u32 v38, s73, v13
    v_mov_b32 v13, 0x2000000
    v_cndmask_b32 v38, v13, v38, vcc
    v_add_u32 v14, 64, v0
    v_mul_u32_u24 v13, 171, v14
    v_lshrrev_b32 v13, 11, v13
    v_mul_u32_u24 v39, 12, v13
    v_sub_u32 v14, v14, v39
    v_cmp_gt_u32 vcc, s99, v14
    v_lshrrev_b32 v14, 3, v13
    v_lshlrev_b32 v14, 1, v14
    v_xor_b32 v14, v0, v14
    v_mul_u32_u24 v13, 2560, v13
    v_lshl_add_u32 v13, v14, 4, v13
    v_add_u32 v39, s73, v13
    v_mov_b32 v13, 0x2000000
    v_cndmask_b32 v39, v13, v39, vcc
    v_add_u32 v14, 128, v0
    v_mul_u32_u24 v13, 171, v14
    v_lshrrev_b32 v13, 11, v13
    v_mul_u32_u24 v40, 12, v13
    v_sub_u32 v14, v14, v40
    v_cmp_gt_u32 vcc, s99, v14
    v_lshrrev_b32 v14, 3, v13
    v_lshlrev_b32 v14, 1, v14
    v_xor_b32 v14, v0, v14
    v_mul_u32_u24 v13, 2560, v13
    v_lshl_add_u32 v13, v14, 4, v13
    v_add_u32 v40, s73, v13
    v_mov_b32 v13, 0x2000000
    v_cndmask_b32 v40, v13, v40, vcc
    s_mul_i32 s101, s65, 6144
    s_waitcnt vmcnt(9) lgkmcnt(0)
    s_barrier
    buffer_load_dwordx4 v34, s[40:43], s98 offen offset:2048 lds
    buffer_load_dwordx4 v35, s[40:43], s98 offen offset:3072 lds
    s_add_u32 m0, s61, 49152
    s_nop 0
    buffer_load_dwordx4 v36, s[48:51], s98 offen offset:0 lds
    buffer_load_dwordx4 v37, s[48:51], s98 offen offset:1024 lds
    s_add_u32 m0, s60, 73728
    s_add_u32 s98, s79, 640
    s_and_b32 s98, s98, 1023
    buffer_load_dwordx4 v32, s[40:43], s98 offen offset:0 lds
    buffer_load_dwordx4 v33, s[40:43], s98 offen offset:1024 lds
    ds_read_b128 v[160:163], v44 offset:0
    ds_read_b128 v[164:167], v44 offset:2048
    ds_read_b128 v[168:171], v45 offset:0
    ds_read_b128 v[172:175], v45 offset:2048
    s_mul_i32 s89, s70, 0
    s_add_u32 s89, s89, s69
    s_and_b32 s89, s89, 7
    s_cmp_eq_u32 s65, 3
    s_cselect_b32 s91, 10, 11
    s_mul_i32 s89, s89, s91
    s_lshr_b32 s89, s89, 3
    s_mul_i32 s90, s65, 11
    s_add_u32 s89, s89, s90
    s_add_u32 s91, s91, s90
    s_lshl_b32 s89, s89, 11
    s_lshl_b32 s90, s90, 11
    s_lshl_b32 s91, s91, 11
    s_waitcnt vmcnt(8) lgkmcnt(0)
    s_barrier
    buffer_load_dwordx4 v34, s[40:43], s98 offen offset:2048 lds
    buffer_load_dwordx4 v35, s[40:43], s98 offen offset:3072 lds
    s_add_u32 m0, s61, 73728
    s_nop 0
    buffer_load_dwordx4 v36, s[48:51], s98 offen offset:0 lds
    buffer_load_dwordx4 v37, s[48:51], s98 offen offset:1024 lds
    s_add_u32 m0, s60, 98304
    s_add_u32 s98, s79, 768
    s_and_b32 s98, s98, 1023
    buffer_load_dwordx4 v32, s[40:43], s98 offen offset:0 lds
    buffer_load_dwordx4 v33, s[40:43], s98 offen offset:1024 lds
    ds_read_b128 v[176:179], v44 offset:24576
    ds_read_b128 v[180:183], v44 offset:26624
    ds_read_b128 v[184:187], v45 offset:24576
    ds_read_b128 v[188:191], v45 offset:26624
    s_lshl_b32 s86, s89, 4
    s_lshl_b32 s87, s90, 4
    s_lshl_b32 s88, s91, 4
    s_add_u32 s86, s86, 16384
    s_add_u32 s86, s86, 16384
    s_cmp_eq_u32 s86, s88
    s_cselect_b32 s86, s87, s86
    s_add_u32 s86, s86, 16384
    s_waitcnt vmcnt(8) lgkmcnt(0)
    s_barrier
    buffer_load_dwordx4 v34, s[40:43], s98 offen offset:2048 lds
    buffer_load_dwordx4 v35, s[40:43], s98 offen offset:3072 lds
    s_add_u32 m0, s61, 98304
    s_nop 0
    buffer_load_dwordx4 v36, s[48:51], s98 offen offset:0 lds
    buffer_load_dwordx4 v37, s[48:51], s98 offen offset:1024 lds
    s_add_u32 m0, s60, 122880
    s_add_u32 s98, s79, 896
    s_and_b32 s98, s98, 1023
    buffer_load_dwordx4 v32, s[40:43], s98 offen offset:0 lds
    buffer_load_dwordx4 v33, s[40:43], s98 offen offset:1024 lds
    ds_read_b128 v[192:195], v46 offset:0
    ds_read_b128 v[196:199], v46 offset:2048
    ds_read_b128 v[200:203], v47 offset:0
    ds_read_b128 v[204:207], v47 offset:2048
    v_readfirstlane_b32 s71, v42
    s_nop 1
    s_add_u32 s71, s71, 0x9e3779b8
    s_or_b32 s71, s71, 1
    s_mov_b32 s80, 0xbfb8aa3b
    s_mov_b32 s81, 0xbfb8aa3b
    s_waitcnt vmcnt(8) lgkmcnt(0)
    s_barrier
    buffer_load_dwordx4 v34, s[40:43], s98 offen offset:2048 lds
    buffer_load_dwordx4 v35, s[40:43], s98 offen offset:3072 lds
    s_add_u32 m0, s61, 122880
    s_nop 0
    buffer_load_dwordx4 v36, s[48:51], s98 offen offset:0 lds
    buffer_load_dwordx4 v37, s[48:51], s98 offen offset:1024 lds
    s_add_u32 m0, s101, 0
    s_add_u32 s99, s68, 0
    s_and_b32 s99, s99, 7
    s_mul_i32 s99, s99, 176128
    buffer_load_dwordx4 v38, s[52:55], s99 offen offset:0 lds
    buffer_load_dwordx4 v39, s[52:55], s99 offen offset:1024 lds
    ds_read_b128 v[208:211], v46 offset:24576
    ds_read_b128 v[212:215], v46 offset:26624
    ds_read_b128 v[216:219], v47 offset:24576
    ds_read_b128 v[220:223], v47 offset:26624
    s_lshl_b32 s73, s66, 2
    s_add_u32 s73, s73, s65
    s_mul_i32 s74, s73, 43
    s_add_u32 s74, s74, s72
    s_add_u32 s74, s74, 0
    s_lshl_b32 s75, s74, 11
    s_lshr_b32 s74, s73, 1
    s_lshl4_add_u32 s74, s74, s67
    s_and_b32 s73, s73, 1
    s_lshl1_add_u32 s74, s74, s73
    s_mul_i32 s74, s74, 8
    s_add_u32 s76, s74, 0xb24000
    s_waitcnt vmcnt(8) lgkmcnt(0)
    s_barrier
    buffer_load_dwordx4 v40, s[52:55], s99 offen offset:2048 lds
    s_add_u32 m0, s101, 3072
    s_add_u32 s99, s99, 44032
    buffer_load_dwordx4 v38, s[52:55], s99 offen offset:0 lds
    buffer_load_dwordx4 v39, s[52:55], s99 offen offset:1024 lds
    buffer_load_dwordx4 v40, s[52:55], s99 offen offset:2048 lds
    ds_read_b128 v[224:227], v48 offset:0
    ds_read_b128 v[228:231], v48 offset:2048
    ds_read_b128 v[232:235], v49 offset:0
    ds_read_b128 v[236:239], v49 offset:2048
    s_add_u32 s77, s75, 4096
    s_and_b32 s73, s67, 3
    s_cmp_eq_u32 s73, 3
    s_cselect_b32 s73, 14, s67
    s_cmp_eq_u32 s73, 14
    s_cselect_b32 s77, 0x2000000, s77
    v_mov_b32 v7, 151552
    v_mov_b32 v6, 1
    s_waitcnt vmcnt(6) lgkmcnt(0)
    s_barrier
    s_add_u32 m0, s101, 24576
    s_add_u32 s99, s68, 1
    s_and_b32 s99, s99, 7
    s_mul_i32 s99, s99, 176128
    buffer_load_dwordx4 v38, s[52:55], s99 offen offset:0 lds
    buffer_load_dwordx4 v39, s[52:55], s99 offen offset:1024 lds
    buffer_load_dwordx4 v40, s[52:55], s99 offen offset:2048 lds
    s_add_u32 m0, s101, 27648
    s_add_u32 s99, s99, 44032
    buffer_load_dwordx4 v38, s[52:55], s99 offen offset:0 lds
    buffer_load_dwordx4 v39, s[52:55], s99 offen offset:1024 lds
    buffer_load_dwordx4 v40, s[52:55], s99 offen offset:2048 lds
    ds_read_b128 v[240:243], v48 offset:24576
    ds_read_b128 v[244:247], v48 offset:26624
    ds_read_b128 v[248:251], v49 offset:24576
    ds_read_b128 v[252:255], v49 offset:26624
    s_waitcnt vmcnt(6) lgkmcnt(0)
    s_barrier
    ds_read_b64_tr_b16 v[8:9], v2 offset:0
    ds_read_b64_tr_b16 v[10:11], v2 offset:768
    ds_read_b64_tr_b16 v[12:13], v2 offset:6144
    ds_read_b64_tr_b16 v[14:15], v2 offset:6912
    ds_read_b64_tr_b16 v[16:17], v3 offset:0
    ds_read_b64_tr_b16 v[18:19], v3 offset:768
    ds_read_b64_tr_b16 v[20:21], v3 offset:6144
    ds_read_b64_tr_b16 v[22:23], v3 offset:6912
    s_waitcnt lgkmcnt(4)
    v_mfma_f32_16x16x32_bf16 v[32:35], v[8:11], v[128:131], 0
    ds_read_b64_tr_b16 v[24:25], v2 offset:12288
    v_mfma_f32_16x16x32_bf16 v[32:35], v[12:15], v[136:139], v[32:35]
    ds_read_b64_tr_b16 v[26:27], v2 offset:13056
    v_mfma_f32_16x16x32_bf16 v[40:43], v[12:15], v[140:143], 0
    ds_read_b64_tr_b16 v[28:29], v2 offset:18432
    v_mfma_f32_16x16x32_bf16 v[40:43], v[8:11], v[132:135], v[40:43]
    ds_read_b64_tr_b16 v[30:31], v2 offset:19200
    s_waitcnt lgkmcnt(4)
    v_mfma_f32_16x16x32_bf16 v[44:47], v[16:19], v[132:135], 0
    ds_read_b64_tr_b16 v[8:9], v3 offset:12288
    v_mfma_f32_16x16x32_bf16 v[44:47], v[20:23], v[140:143], v[44:47]
    ds_read_b64_tr_b16 v[10:11], v3 offset:13056
    v_mfma_f32_16x16x32_bf16 v[36:39], v[20:23], v[136:139], 0
    ds_read_b64_tr_b16 v[12:13], v3 offset:18432
    v_mfma_f32_16x16x32_bf16 v[36:39], v[16:19], v[128:131], v[36:39]
    ds_read_b64_tr_b16 v[14:15], v3 offset:19200
    s_waitcnt lgkmcnt(4)
    v_mfma_f32_16x16x32_bf16 v[48:51], v[24:27], v[128:131], 0
    ds_read_b64_tr_b16 v[16:17], v2 offset:64
    v_mfma_f32_16x16x32_bf16 v[48:51], v[28:31], v[136:139], v[48:51]
    ds_read_b64_tr_b16 v[18:19], v2 offset:832
    v_mfma_f32_16x16x32_bf16 v[56:59], v[28:31], v[140:143], 0
    ds_read_b64_tr_b16 v[20:21], v2 offset:6208
    v_mfma_f32_16x16x32_bf16 v[56:59], v[24:27], v[132:135], v[56:59]
    ds_read_b64_tr_b16 v[22:23], v2 offset:6976
    s_waitcnt lgkmcnt(4)
    v_mfma_f32_16x16x32_bf16 v[60:63], v[8:11], v[132:135], 0
    ds_read_b64_tr_b16 v[24:25], v3 offset:64
    v_mfma_f32_16x16x32_bf16 v[60:63], v[12:15], v[140:143], v[60:63]
    ds_read_b64_tr_b16 v[26:27], v3 offset:832
    v_mfma_f32_16x16x32_bf16 v[52:55], v[12:15], v[136:139], 0
    ds_read_b64_tr_b16 v[28:29], v3 offset:6208
    v_mfma_f32_16x16x32_bf16 v[52:55], v[8:11], v[128:131], v[52:55]
    ds_read_b64_tr_b16 v[30:31], v3 offset:6976
    s_waitcnt lgkmcnt(4)
    v_mfma_f32_16x16x32_bf16 v[64:67], v[16:19], v[128:131], 0
    ds_read_b64_tr_b16 v[8:9], v2 offset:12352
    v_mfma_f32_16x16x32_bf16 v[64:67], v[20:23], v[136:139], v[64:67]
    ds_read_b64_tr_b16 v[10:11], v2 offset:13120
    v_mfma_f32_16x16x32_bf16 v[72:75], v[20:23], v[140:143], 0
    ds_read_b64_tr_b16 v[12:13], v2 offset:18496
    v_mfma_f32_16x16x32_bf16 v[72:75], v[16:19], v[132:135], v[72:75]
    ds_read_b64_tr_b16 v[14:15], v2 offset:19264
    s_waitcnt lgkmcnt(4)
    v_mfma_f32_16x16x32_bf16 v[76:79], v[24:27], v[132:135], 0
    ds_read_b64_tr_b16 v[16:17], v3 offset:12352
    v_mfma_f32_16x16x32_bf16 v[76:79], v[28:31], v[140:143], v[76:79]
    ds_read_b64_tr_b16 v[18:19], v3 offset:13120
    v_mfma_f32_16x16x32_bf16 v[68:71], v[28:31], v[136:139], 0
    ds_read_b64_tr_b16 v[20:21], v3 offset:18496
    v_mfma_f32_16x16x32_bf16 v[68:71], v[24:27], v[128:131], v[68:71]
    ds_read_b64_tr_b16 v[22:23], v3 offset:19264
    s_waitcnt lgkmcnt(4)
    v_mfma_f32_16x16x32_bf16 v[80:83], v[8:11], v[128:131], 0
    ds_read_b64_tr_b16 v[24:25], v2 offset:128
    v_mfma_f32_16x16x32_bf16 v[80:83], v[12:15], v[136:139], v[80:83]
    ds_read_b64_tr_b16 v[26:27], v2 offset:896
    v_mfma_f32_16x16x32_bf16 v[88:91], v[12:15], v[140:143], 0
    ds_read_b64_tr_b16 v[28:29], v2 offset:6272
    v_mfma_f32_16x16x32_bf16 v[88:91], v[8:11], v[132:135], v[88:91]
    ds_read_b64_tr_b16 v[30:31], v2 offset:7040
    s_waitcnt lgkmcnt(4)
    v_mfma_f32_16x16x32_bf16 v[92:95], v[16:19], v[132:135], 0
    ds_read_b64_tr_b16 v[8:9], v3 offset:128
    v_mfma_f32_16x16x32_bf16 v[92:95], v[20:23], v[140:143], v[92:95]
    ds_read_b64_tr_b16 v[10:11], v3 offset:896
    v_mfma_f32_16x16x32_bf16 v[84:87], v[20:23], v[136:139], 0
    ds_read_b64_tr_b16 v[12:13], v3 offset:6272
    v_mfma_f32_16x16x32_bf16 v[84:87], v[16:19], v[128:131], v[84:87]
    ds_read_b64_tr_b16 v[14:15], v3 offset:7040
    s_waitcnt lgkmcnt(4)
    v_mfma_f32_16x16x32_bf16 v[96:99], v[24:27], v[128:131], 0
    ds_read_b64_tr_b16 v[16:17], v2 offset:12416
    v_mfma_f32_16x16x32_bf16 v[96:99], v[28:31], v[136:139], v[96:99]
    ds_read_b64_tr_b16 v[18:19], v2 offset:13184
    v_mfma_f32_16x16x32_bf16 v[104:107], v[28:31], v[140:143], 0
    ds_read_b64_tr_b16 v[20:21], v2 offset:18560
    v_mfma_f32_16x16x32_bf16 v[104:107], v[24:27], v[132:135], v[104:107]
    ds_read_b64_tr_b16 v[22:23], v2 offset:19328
    s_waitcnt lgkmcnt(4)
    v_mfma_f32_16x16x32_bf16 v[108:111], v[8:11], v[132:135], 0
    ds_read_b64_tr_b16 v[24:25], v3 offset:12416
    v_mfma_f32_16x16x32_bf16 v[108:111], v[12:15], v[140:143], v[108:111]
    ds_read_b64_tr_b16 v[26:27], v3 offset:13184
    v_mfma_f32_16x16x32_bf16 v[100:103], v[12:15], v[136:139], 0
    ds_read_b64_tr_b16 v[28:29], v3 offset:18560
    v_mfma_f32_16x16x32_bf16 v[100:103], v[8:11], v[128:131], v[100:103]
    ds_read_b64_tr_b16 v[30:31], v3 offset:19328
    s_waitcnt lgkmcnt(4)
    v_mfma_f32_16x16x32_bf16 v[112:115], v[16:19], v[128:131], 0
    s_waitcnt vmcnt(0)
    s_barrier
    ds_read_b64_tr_b16 v[8:9], v2 offset:24576
    v_mfma_f32_16x16x32_bf16 v[112:115], v[20:23], v[136:139], v[112:115]
    ds_read_b64_tr_b16 v[10:11], v2 offset:25344
    v_mfma_f32_16x16x32_bf16 v[120:123], v[20:23], v[140:143], 0
    ds_read_b64_tr_b16 v[12:13], v2 offset:30720
    v_mfma_f32_16x16x32_bf16 v[120:123], v[16:19], v[132:135], v[120:123]
    ds_read_b64_tr_b16 v[14:15], v2 offset:31488
    s_waitcnt lgkmcnt(4)
    v_mfma_f32_16x16x32_bf16 v[124:127], v[24:27], v[132:135], 0
    ds_read_b64_tr_b16 v[16:17], v3 offset:24576
    v_mfma_f32_16x16x32_bf16 v[124:127], v[28:31], v[140:143], v[124:127]
    ds_read_b64_tr_b16 v[18:19], v3 offset:25344
    v_mfma_f32_16x16x32_bf16 v[116:119], v[28:31], v[136:139], 0
    ds_read_b64_tr_b16 v[20:21], v3 offset:30720
    v_mfma_f32_16x16x32_bf16 v[116:119], v[24:27], v[128:131], v[116:119]
    ds_read_b64_tr_b16 v[22:23], v3 offset:31488
    s_waitcnt lgkmcnt(4)
    v_mfma_f32_16x16x32_bf16 v[32:35], v[8:11], v[144:147], v[32:35]
    ds_read_b64_tr_b16 v[24:25], v2 offset:36864
    v_mfma_f32_16x16x32_bf16 v[32:35], v[12:15], v[152:155], v[32:35]
    ds_read_b64_tr_b16 v[26:27], v2 offset:37632
    v_mfma_f32_16x16x32_bf16 v[40:43], v[12:15], v[156:159], v[40:43]
    ds_read_b64_tr_b16 v[28:29], v2 offset:43008
    v_mfma_f32_16x16x32_bf16 v[40:43], v[8:11], v[148:151], v[40:43]
    ds_read_b64_tr_b16 v[30:31], v2 offset:43776
    s_waitcnt lgkmcnt(4)
    v_mfma_f32_16x16x32_bf16 v[44:47], v[16:19], v[148:151], v[44:47]
    ds_read_b64_tr_b16 v[8:9], v3 offset:36864
    v_mfma_f32_16x16x32_bf16 v[44:47], v[20:23], v[156:159], v[44:47]
    ds_read_b64_tr_b16 v[10:11], v3 offset:37632
    v_mfma_f32_16x16x32_bf16 v[36:39], v[20:23], v[152:155], v[36:39]
    ds_read_b64_tr_b16 v[12:13], v3 offset:43008
    v_mfma_f32_16x16x32_bf16 v[36:39], v[16:19], v[144:147], v[36:39]
    ds_read_b64_tr_b16 v[14:15], v3 offset:43776
    s_waitcnt lgkmcnt(4)
    v_mfma_f32_16x16x32_bf16 v[48:51], v[24:27], v[144:147], v[48:51]
    ds_read_b64_tr_b16 v[16:17], v2 offset:24640
    v_mfma_f32_16x16x32_bf16 v[48:51], v[28:31], v[152:155], v[48:51]
    ds_read_b64_tr_b16 v[18:19], v2 offset:25408
    v_mfma_f32_16x16x32_bf16 v[56:59], v[28:31], v[156:159], v[56:59]
    ds_read_b64_tr_b16 v[20:21], v2 offset:30784
    v_mfma_f32_16x16x32_bf16 v[56:59], v[24:27], v[148:151], v[56:59]
    ds_read_b64_tr_b16 v[22:23], v2 offset:31552
    s_waitcnt lgkmcnt(4)
    v_mfma_f32_16x16x32_bf16 v[60:63], v[8:11], v[148:151], v[60:63]
    ds_read_b64_tr_b16 v[24:25], v3 offset:24640
    v_mfma_f32_16x16x32_bf16 v[60:63], v[12:15], v[156:159], v[60:63]
    ds_read_b64_tr_b16 v[26:27], v3 offset:25408
    v_mfma_f32_16x16x32_bf16 v[52:55], v[12:15], v[152:155], v[52:55]
    ds_read_b64_tr_b16 v[28:29], v3 offset:30784
    v_mfma_f32_16x16x32_bf16 v[52:55], v[8:11], v[144:147], v[52:55]
    ds_read_b64_tr_b16 v[30:31], v3 offset:31552
    s_waitcnt lgkmcnt(4)
    v_mfma_f32_16x16x32_bf16 v[64:67], v[16:19], v[144:147], v[64:67]
    ds_read_b64_tr_b16 v[8:9], v2 offset:36928
    v_mfma_f32_16x16x32_bf16 v[64:67], v[20:23], v[152:155], v[64:67]
    ds_read_b64_tr_b16 v[10:11], v2 offset:37696
    v_mfma_f32_16x16x32_bf16 v[72:75], v[20:23], v[156:159], v[72:75]
    ds_read_b64_tr_b16 v[12:13], v2 offset:43072
    v_mfma_f32_16x16x32_bf16 v[72:75], v[16:19], v[148:151], v[72:75]
    ds_read_b64_tr_b16 v[14:15], v2 offset:43840
    s_waitcnt lgkmcnt(4)
    v_mfma_f32_16x16x32_bf16 v[76:79], v[24:27], v[148:151], v[76:79]
    ds_read_b64_tr_b16 v[16:17], v3 offset:36928
    v_mfma_f32_16x16x32_bf16 v[76:79], v[28:31], v[156:159], v[76:79]
    ds_read_b64_tr_b16 v[18:19], v3 offset:37696
    v_mfma_f32_16x16x32_bf16 v[68:71], v[28:31], v[152:155], v[68:71]
    ds_read_b64_tr_b16 v[20:21], v3 offset:43072
    v_mfma_f32_16x16x32_bf16 v[68:71], v[24:27], v[144:147], v[68:71]
    ds_read_b64_tr_b16 v[22:23], v3 offset:43840
    s_waitcnt lgkmcnt(4)
    v_mfma_f32_16x16x32_bf16 v[80:83], v[8:11], v[144:147], v[80:83]
    ds_read_b64_tr_b16 v[24:25], v2 offset:24704
    v_mfma_f32_16x16x32_bf16 v[80:83], v[12:15], v[152:155], v[80:83]
    ds_read_b64_tr_b16 v[26:27], v2 offset:25472
    v_mfma_f32_16x16x32_bf16 v[88:91], v[12:15], v[156:159], v[88:91]
    ds_read_b64_tr_b16 v[28:29], v2 offset:30848
    v_mfma_f32_16x16x32_bf16 v[88:91], v[8:11], v[148:151], v[88:91]
    ds_read_b64_tr_b16 v[30:31], v2 offset:31616
    s_waitcnt lgkmcnt(4)
    v_mfma_f32_16x16x32_bf16 v[92:95], v[16:19], v[148:151], v[92:95]
    ds_read_b64_tr_b16 v[8:9], v3 offset:24704
    v_mfma_f32_16x16x32_bf16 v[92:95], v[20:23], v[156:159], v[92:95]
    ds_read_b64_tr_b16 v[10:11], v3 offset:25472
    v_mfma_f32_16x16x32_bf16 v[84:87], v[20:23], v[152:155], v[84:87]
    ds_read_b64_tr_b16 v[12:13], v3 offset:30848
    v_mfma_f32_16x16x32_bf16 v[84:87], v[16:19], v[144:147], v[84:87]
    ds_read_b64_tr_b16 v[14:15], v3 offset:31616
    s_waitcnt lgkmcnt(4)
    v_mfma_f32_16x16x32_bf16 v[96:99], v[24:27], v[144:147], v[96:99]
    ds_read_b64_tr_b16 v[16:17], v2 offset:36992
    v_mfma_f32_16x16x32_bf16 v[96:99], v[28:31], v[152:155], v[96:99]
    ds_read_b64_tr_b16 v[18:19], v2 offset:37760
    v_mfma_f32_16x16x32_bf16 v[104:107], v[28:31], v[156:159], v[104:107]
    ds_read_b64_tr_b16 v[20:21], v2 offset:43136
    v_mfma_f32_16x16x32_bf16 v[104:107], v[24:27], v[148:151], v[104:107]
    ds_read_b64_tr_b16 v[22:23], v2 offset:43904
    s_waitcnt lgkmcnt(4)
    v_mfma_f32_16x16x32_bf16 v[108:111], v[8:11], v[148:151], v[108:111]
    ds_read_b64_tr_b16 v[24:25], v3 offset:36992
    v_mfma_f32_16x16x32_bf16 v[108:111], v[12:15], v[156:159], v[108:111]
    ds_read_b64_tr_b16 v[26:27], v3 offset:37760
    v_mfma_f32_16x16x32_bf16 v[100:103], v[12:15], v[152:155], v[100:103]
    ds_read_b64_tr_b16 v[28:29], v3 offset:43136
    v_mfma_f32_16x16x32_bf16 v[100:103], v[8:11], v[144:147], v[100:103]
    ds_read_b64_tr_b16 v[30:31], v3 offset:43904
    s_waitcnt lgkmcnt(4)
    v_mfma_f32_16x16x32_bf16 v[112:115], v[16:19], v[144:147], v[112:115]
    s_barrier
    ds_read_b64_tr_b16 v[8:9], v4 offset:0
    v_mfma_f32_16x16x32_bf16 v[112:115], v[20:23], v[152:155], v[112:115]
    ds_read_b64_tr_b16 v[10:11], v4 offset:768
    v_mfma_f32_16x16x32_bf16 v[120:123], v[20:23], v[156:159], v[120:123]
    ds_read_b64_tr_b16 v[12:13], v4 offset:6144
    v_mfma_f32_16x16x32_bf16 v[120:123], v[16:19], v[148:151], v[120:123]
    ds_read_b64_tr_b16 v[14:15], v4 offset:6912
    s_waitcnt lgkmcnt(4)
    v_mfma_f32_16x16x32_bf16 v[124:127], v[24:27], v[148:151], v[124:127]
    ds_read_b64_tr_b16 v[16:17], v5 offset:0
    v_mfma_f32_16x16x32_bf16 v[124:127], v[28:31], v[156:159], v[124:127]
    ds_read_b64_tr_b16 v[18:19], v5 offset:768
    v_mfma_f32_16x16x32_bf16 v[116:119], v[28:31], v[152:155], v[116:119]
    ds_read_b64_tr_b16 v[20:21], v5 offset:6144
    v_mfma_f32_16x16x32_bf16 v[116:119], v[24:27], v[144:147], v[116:119]
    ds_read_b64_tr_b16 v[22:23], v5 offset:6912
    s_waitcnt lgkmcnt(4)
    v_mfma_f32_16x16x32_bf16 v[32:35], v[8:11], v[160:163], v[32:35]
    ds_read_b64_tr_b16 v[24:25], v4 offset:12288
    v_mfma_f32_16x16x32_bf16 v[32:35], v[12:15], v[168:171], v[32:35]
    ds_read_b64_tr_b16 v[26:27], v4 offset:13056
    v_mfma_f32_16x16x32_bf16 v[40:43], v[12:15], v[172:175], v[40:43]
    ds_read_b64_tr_b16 v[28:29], v4 offset:18432
    v_mfma_f32_16x16x32_bf16 v[40:43], v[8:11], v[164:167], v[40:43]
    ds_read_b64_tr_b16 v[30:31], v4 offset:19200
    s_waitcnt lgkmcnt(4)
    v_mfma_f32_16x16x32_bf16 v[44:47], v[16:19], v[164:167], v[44:47]
    ds_read_b64_tr_b16 v[8:9], v5 offset:12288
    v_mfma_f32_16x16x32_bf16 v[44:47], v[20:23], v[172:175], v[44:47]
    ds_read_b64_tr_b16 v[10:11], v5 offset:13056
    v_mfma_f32_16x16x32_bf16 v[36:39], v[20:23], v[168:171], v[36:39]
    ds_read_b64_tr_b16 v[12:13], v5 offset:18432
    v_mfma_f32_16x16x32_bf16 v[36:39], v[16:19], v[160:163], v[36:39]
    ds_read_b64_tr_b16 v[14:15], v5 offset:19200
    s_waitcnt lgkmcnt(4)
    v_mfma_f32_16x16x32_bf16 v[48:51], v[24:27], v[160:163], v[48:51]
    ds_read_b64_tr_b16 v[16:17], v4 offset:64
    v_mfma_f32_16x16x32_bf16 v[48:51], v[28:31], v[168:171], v[48:51]
    ds_read_b64_tr_b16 v[18:19], v4 offset:832
    v_mfma_f32_16x16x32_bf16 v[56:59], v[28:31], v[172:175], v[56:59]
    ds_read_b64_tr_b16 v[20:21], v4 offset:6208
    v_mfma_f32_16x16x32_bf16 v[56:59], v[24:27], v[164:167], v[56:59]
    ds_read_b64_tr_b16 v[22:23], v4 offset:6976
    s_waitcnt lgkmcnt(4)
    v_mfma_f32_16x16x32_bf16 v[60:63], v[8:11], v[164:167], v[60:63]
    ds_read_b64_tr_b16 v[24:25], v5 offset:64
    v_mfma_f32_16x16x32_bf16 v[60:63], v[12:15], v[172:175], v[60:63]
    ds_read_b64_tr_b16 v[26:27], v5 offset:832
    v_mfma_f32_16x16x32_bf16 v[52:55], v[12:15], v[168:171], v[52:55]
    ds_read_b64_tr_b16 v[28:29], v5 offset:6208
    v_mfma_f32_16x16x32_bf16 v[52:55], v[8:11], v[160:163], v[52:55]
    ds_read_b64_tr_b16 v[30:31], v5 offset:6976
    s_waitcnt lgkmcnt(4)
    v_mfma_f32_16x16x32_bf16 v[64:67], v[16:19], v[160:163], v[64:67]
    ds_read_b64_tr_b16 v[8:9], v4 offset:12352
    v_mfma_f32_16x16x32_bf16 v[64:67], v[20:23], v[168:171], v[64:67]
    ds_read_b64_tr_b16 v[10:11], v4 offset:13120
    v_mfma_f32_16x16x32_bf16 v[72:75], v[20:23], v[172:175], v[72:75]
    ds_read_b64_tr_b16 v[12:13], v4 offset:18496
    v_mfma_f32_16x16x32_bf16 v[72:75], v[16:19], v[164:167], v[72:75]
    ds_read_b64_tr_b16 v[14:15], v4 offset:19264
    s_waitcnt lgkmcnt(4)
    v_mfma_f32_16x16x32_bf16 v[76:79], v[24:27], v[164:167], v[76:79]
    ds_read_b64_tr_b16 v[16:17], v5 offset:12352
    v_mfma_f32_16x16x32_bf16 v[76:79], v[28:31], v[172:175], v[76:79]
    ds_read_b64_tr_b16 v[18:19], v5 offset:13120
    v_mfma_f32_16x16x32_bf16 v[68:71], v[28:31], v[168:171], v[68:71]
    ds_read_b64_tr_b16 v[20:21], v5 offset:18496
    v_mfma_f32_16x16x32_bf16 v[68:71], v[24:27], v[160:163], v[68:71]
    ds_read_b64_tr_b16 v[22:23], v5 offset:19264
    s_waitcnt lgkmcnt(4)
    v_mfma_f32_16x16x32_bf16 v[80:83], v[8:11], v[160:163], v[80:83]
    ds_read_b64_tr_b16 v[24:25], v4 offset:128
    v_mfma_f32_16x16x32_bf16 v[80:83], v[12:15], v[168:171], v[80:83]
    ds_read_b64_tr_b16 v[26:27], v4 offset:896
    v_mfma_f32_16x16x32_bf16 v[88:91], v[12:15], v[172:175], v[88:91]
    ds_read_b64_tr_b16 v[28:29], v4 offset:6272
    v_mfma_f32_16x16x32_bf16 v[88:91], v[8:11], v[164:167], v[88:91]
    ds_read_b64_tr_b16 v[30:31], v4 offset:7040
    s_waitcnt lgkmcnt(4)
    v_mfma_f32_16x16x32_bf16 v[92:95], v[16:19], v[164:167], v[92:95]
    ds_read_b64_tr_b16 v[8:9], v5 offset:128
    v_mfma_f32_16x16x32_bf16 v[92:95], v[20:23], v[172:175], v[92:95]
    ds_read_b64_tr_b16 v[10:11], v5 offset:896
    v_mfma_f32_16x16x32_bf16 v[84:87], v[20:23], v[168:171], v[84:87]
    ds_read_b64_tr_b16 v[12:13], v5 offset:6272
    v_mfma_f32_16x16x32_bf16 v[84:87], v[16:19], v[160:163], v[84:87]
    ds_read_b64_tr_b16 v[14:15], v5 offset:7040
    s_waitcnt lgkmcnt(4)
    v_mfma_f32_16x16x32_bf16 v[96:99], v[24:27], v[160:163], v[96:99]
    ds_read_b64_tr_b16 v[16:17], v4 offset:12416
    v_mfma_f32_16x16x32_bf16 v[96:99], v[28:31], v[168:171], v[96:99]
    ds_read_b64_tr_b16 v[18:19], v4 offset:13184
    v_mfma_f32_16x16x32_bf16 v[104:107], v[28:31], v[172:175], v[104:107]
    ds_read_b64_tr_b16 v[20:21], v4 offset:18560
    v_mfma_f32_16x16x32_bf16 v[104:107], v[24:27], v[164:167], v[104:107]
    ds_read_b64_tr_b16 v[22:23], v4 offset:19328
    s_waitcnt lgkmcnt(4)
    v_mfma_f32_16x16x32_bf16 v[108:111], v[8:11], v[164:167], v[108:111]
    ds_read_b64_tr_b16 v[24:25], v5 offset:12416
    v_mfma_f32_16x16x32_bf16 v[108:111], v[12:15], v[172:175], v[108:111]
    ds_read_b64_tr_b16 v[26:27], v5 offset:13184
    v_mfma_f32_16x16x32_bf16 v[100:103], v[12:15], v[168:171], v[100:103]
    ds_read_b64_tr_b16 v[28:29], v5 offset:18560
    v_mfma_f32_16x16x32_bf16 v[100:103], v[8:11], v[160:163], v[100:103]
    ds_read_b64_tr_b16 v[30:31], v5 offset:19328
    s_waitcnt lgkmcnt(4)
    v_mfma_f32_16x16x32_bf16 v[112:115], v[16:19], v[160:163], v[112:115]
    s_barrier
    ds_read_b64_tr_b16 v[8:9], v4 offset:24576
    v_mfma_f32_16x16x32_bf16 v[112:115], v[20:23], v[168:171], v[112:115]
    ds_read_b64_tr_b16 v[10:11], v4 offset:25344
    v_mfma_f32_16x16x32_bf16 v[120:123], v[20:23], v[172:175], v[120:123]
    ds_read_b64_tr_b16 v[12:13], v4 offset:30720
    v_mfma_f32_16x16x32_bf16 v[120:123], v[16:19], v[164:167], v[120:123]
    ds_read_b64_tr_b16 v[14:15], v4 offset:31488
    s_waitcnt lgkmcnt(4)
    v_mfma_f32_16x16x32_bf16 v[124:127], v[24:27], v[164:167], v[124:127]
    ds_read_b64_tr_b16 v[16:17], v5 offset:24576
    v_mfma_f32_16x16x32_bf16 v[124:127], v[28:31], v[172:175], v[124:127]
    ds_read_b64_tr_b16 v[18:19], v5 offset:25344
    v_mfma_f32_16x16x32_bf16 v[116:119], v[28:31], v[168:171], v[116:119]
    ds_read_b64_tr_b16 v[20:21], v5 offset:30720
    v_mfma_f32_16x16x32_bf16 v[116:119], v[24:27], v[160:163], v[116:119]
    ds_read_b64_tr_b16 v[22:23], v5 offset:31488
    s_waitcnt lgkmcnt(4)
    v_mfma_f32_16x16x32_bf16 v[32:35], v[8:11], v[176:179], v[32:35]
    ds_read_b64_tr_b16 v[24:25], v4 offset:36864
    v_mfma_f32_16x16x32_bf16 v[32:35], v[12:15], v[184:187], v[32:35]
    ds_read_b64_tr_b16 v[26:27], v4 offset:37632
    v_mfma_f32_16x16x32_bf16 v[40:43], v[12:15], v[188:191], v[40:43]
    ds_read_b64_tr_b16 v[28:29], v4 offset:43008
    v_mfma_f32_16x16x32_bf16 v[40:43], v[8:11], v[180:183], v[40:43]
    ds_read_b64_tr_b16 v[30:31], v4 offset:43776
    s_waitcnt lgkmcnt(4)
    v_mfma_f32_16x16x32_bf16 v[44:47], v[16:19], v[180:183], v[44:47]
    ds_read_b64_tr_b16 v[8:9], v5 offset:36864
    v_mfma_f32_16x16x32_bf16 v[44:47], v[20:23], v[188:191], v[44:47]
    ds_read_b64_tr_b16 v[10:11], v5 offset:37632
    v_mfma_f32_16x16x32_bf16 v[36:39], v[20:23], v[184:187], v[36:39]
    ds_read_b64_tr_b16 v[12:13], v5 offset:43008
    v_mfma_f32_16x16x32_bf16 v[36:39], v[16:19], v[176:179], v[36:39]
    ds_read_b64_tr_b16 v[14:15], v5 offset:43776
    s_waitcnt lgkmcnt(4)
    v_mfma_f32_16x16x32_bf16 v[48:51], v[24:27], v[176:179], v[48:51]
    ds_read_b64_tr_b16 v[16:17], v4 offset:24640
    v_mfma_f32_16x16x32_bf16 v[48:51], v[28:31], v[184:187], v[48:51]
    ds_read_b64_tr_b16 v[18:19], v4 offset:25408
    v_mfma_f32_16x16x32_bf16 v[56:59], v[28:31], v[188:191], v[56:59]
    ds_read_b64_tr_b16 v[20:21], v4 offset:30784
    v_mfma_f32_16x16x32_bf16 v[56:59], v[24:27], v[180:183], v[56:59]
    ds_read_b64_tr_b16 v[22:23], v4 offset:31552
    s_waitcnt lgkmcnt(4)
    v_mfma_f32_16x16x32_bf16 v[60:63], v[8:11], v[180:183], v[60:63]
    ds_read_b64_tr_b16 v[24:25], v5 offset:24640
    v_mfma_f32_16x16x32_bf16 v[60:63], v[12:15], v[188:191], v[60:63]
    ds_read_b64_tr_b16 v[26:27], v5 offset:25408
    v_mfma_f32_16x16x32_bf16 v[52:55], v[12:15], v[184:187], v[52:55]
    ds_read_b64_tr_b16 v[28:29], v5 offset:30784
    v_mfma_f32_16x16x32_bf16 v[52:55], v[8:11], v[176:179], v[52:55]
    ds_read_b64_tr_b16 v[30:31], v5 offset:31552
    s_waitcnt lgkmcnt(4)
    v_mfma_f32_16x16x32_bf16 v[64:67], v[16:19], v[176:179], v[64:67]
    ds_read_b64_tr_b16 v[8:9], v4 offset:36928
    v_mfma_f32_16x16x32_bf16 v[64:67], v[20:23], v[184:187], v[64:67]
    ds_read_b64_tr_b16 v[10:11], v4 offset:37696
    v_mfma_f32_16x16x32_bf16 v[72:75], v[20:23], v[188:191], v[72:75]
    ds_read_b64_tr_b16 v[12:13], v4 offset:43072
    v_mfma_f32_16x16x32_bf16 v[72:75], v[16:19], v[180:183], v[72:75]
    ds_read_b64_tr_b16 v[14:15], v4 offset:43840
    s_waitcnt lgkmcnt(4)
    v_mfma_f32_16x16x32_bf16 v[76:79], v[24:27], v[180:183], v[76:79]
    ds_read_b64_tr_b16 v[16:17], v5 offset:36928
    v_mfma_f32_16x16x32_bf16 v[76:79], v[28:31], v[188:191], v[76:79]
    ds_read_b64_tr_b16 v[18:19], v5 offset:37696
    v_mfma_f32_16x16x32_bf16 v[68:71], v[28:31], v[184:187], v[68:71]
    ds_read_b64_tr_b16 v[20:21], v5 offset:43072
    v_mfma_f32_16x16x32_bf16 v[68:71], v[24:27], v[176:179], v[68:71]
    ds_read_b64_tr_b16 v[22:23], v5 offset:43840
    s_waitcnt lgkmcnt(4)
    v_mfma_f32_16x16x32_bf16 v[80:83], v[8:11], v[176:179], v[80:83]
    ds_read_b64_tr_b16 v[24:25], v4 offset:24704
    v_mfma_f32_16x16x32_bf16 v[80:83], v[12:15], v[184:187], v[80:83]
    ds_read_b64_tr_b16 v[26:27], v4 offset:25472
    v_mfma_f32_16x16x32_bf16 v[88:91], v[12:15], v[188:191], v[88:91]
    ds_read_b64_tr_b16 v[28:29], v4 offset:30848
    v_mfma_f32_16x16x32_bf16 v[88:91], v[8:11], v[180:183], v[88:91]
    ds_read_b64_tr_b16 v[30:31], v4 offset:31616
    s_waitcnt lgkmcnt(4)
    v_mfma_f32_16x16x32_bf16 v[92:95], v[16:19], v[180:183], v[92:95]
    ds_read_b64_tr_b16 v[8:9], v5 offset:24704
    v_mfma_f32_16x16x32_bf16 v[92:95], v[20:23], v[188:191], v[92:95]
    ds_read_b64_tr_b16 v[10:11], v5 offset:25472
    v_mfma_f32_16x16x32_bf16 v[84:87], v[20:23], v[184:187], v[84:87]
    ds_read_b64_tr_b16 v[12:13], v5 offset:30848
    v_mfma_f32_16x16x32_bf16 v[84:87], v[16:19], v[176:179], v[84:87]
    ds_read_b64_tr_b16 v[14:15], v5 offset:31616
    s_waitcnt lgkmcnt(4)
    v_mfma_f32_16x16x32_bf16 v[96:99], v[24:27], v[176:179], v[96:99]
    ds_read_b64_tr_b16 v[16:17], v4 offset:36992
    v_mfma_f32_16x16x32_bf16 v[96:99], v[28:31], v[184:187], v[96:99]
    ds_read_b64_tr_b16 v[18:19], v4 offset:37760
    v_mfma_f32_16x16x32_bf16 v[104:107], v[28:31], v[188:191], v[104:107]
    ds_read_b64_tr_b16 v[20:21], v4 offset:43136
    v_mfma_f32_16x16x32_bf16 v[104:107], v[24:27], v[180:183], v[104:107]
    ds_read_b64_tr_b16 v[22:23], v4 offset:43904
    s_waitcnt lgkmcnt(4)
    v_mfma_f32_16x16x32_bf16 v[108:111], v[8:11], v[180:183], v[108:111]
    ds_read_b64_tr_b16 v[24:25], v5 offset:36992
    v_mfma_f32_16x16x32_bf16 v[108:111], v[12:15], v[188:191], v[108:111]
    ds_read_b64_tr_b16 v[26:27], v5 offset:37760
    v_mfma_f32_16x16x32_bf16 v[100:103], v[12:15], v[184:187], v[100:103]
    ds_read_b64_tr_b16 v[28:29], v5 offset:43136
    v_mfma_f32_16x16x32_bf16 v[100:103], v[8:11], v[176:179], v[100:103]
    ds_read_b64_tr_b16 v[30:31], v5 offset:43904
    s_waitcnt lgkmcnt(4)
    v_mfma_f32_16x16x32_bf16 v[112:115], v[16:19], v[176:179], v[112:115]
    s_barrier
    ds_read_b64_tr_b16 v[8:9], v2 offset:0
    v_mfma_f32_16x16x32_bf16 v[112:115], v[20:23], v[184:187], v[112:115]
    ds_read_b64_tr_b16 v[10:11], v2 offset:768
    v_mfma_f32_16x16x32_bf16 v[120:123], v[20:23], v[188:191], v[120:123]
    ds_read_b64_tr_b16 v[12:13], v2 offset:6144
    v_mfma_f32_16x16x32_bf16 v[120:123], v[16:19], v[180:183], v[120:123]
    ds_read_b64_tr_b16 v[14:15], v2 offset:6912
    s_waitcnt lgkmcnt(4)
    v_mfma_f32_16x16x32_bf16 v[124:127], v[24:27], v[180:183], v[124:127]
    ds_read_b64_tr_b16 v[16:17], v3 offset:0
    v_mfma_f32_16x16x32_bf16 v[124:127], v[28:31], v[188:191], v[124:127]
    ds_read_b64_tr_b16 v[18:19], v3 offset:768
    v_mfma_f32_16x16x32_bf16 v[116:119], v[28:31], v[184:187], v[116:119]
    ds_read_b64_tr_b16 v[20:21], v3 offset:6144
    v_mfma_f32_16x16x32_bf16 v[116:119], v[24:27], v[176:179], v[116:119]
    ds_read_b64_tr_b16 v[22:23], v3 offset:6912
    s_waitcnt lgkmcnt(4)
    v_mfma_f32_16x16x32_bf16 v[32:35], v[8:11], v[192:195], v[32:35]
    ds_read_b64_tr_b16 v[24:25], v2 offset:12288
    v_mfma_f32_16x16x32_bf16 v[32:35], v[12:15], v[200:203], v[32:35]
    ds_read_b64_tr_b16 v[26:27], v2 offset:13056
    v_mfma_f32_16x16x32_bf16 v[40:43], v[12:15], v[204:207], v[40:43]
    ds_read_b64_tr_b16 v[28:29], v2 offset:18432
    v_mfma_f32_16x16x32_bf16 v[40:43], v[8:11], v[196:199], v[40:43]
    ds_read_b64_tr_b16 v[30:31], v2 offset:19200
    s_waitcnt lgkmcnt(4)
    v_mfma_f32_16x16x32_bf16 v[44:47], v[16:19], v[196:199], v[44:47]
    ds_read_b64_tr_b16 v[8:9], v3 offset:12288
    v_mfma_f32_16x16x32_bf16 v[44:47], v[20:23], v[204:207], v[44:47]
    ds_read_b64_tr_b16 v[10:11], v3 offset:13056
    v_mfma_f32_16x16x32_bf16 v[36:39], v[20:23], v[200:203], v[36:39]
    ds_read_b64_tr_b16 v[12:13], v3 offset:18432
    v_mfma_f32_16x16x32_bf16 v[36:39], v[16:19], v[192:195], v[36:39]
    ds_read_b64_tr_b16 v[14:15], v3 offset:19200
    s_waitcnt lgkmcnt(4)
    v_mfma_f32_16x16x32_bf16 v[48:51], v[24:27], v[192:195], v[48:51]
    ds_read_b64_tr_b16 v[16:17], v2 offset:64
    v_mfma_f32_16x16x32_bf16 v[48:51], v[28:31], v[200:203], v[48:51]
    ds_read_b64_tr_b16 v[18:19], v2 offset:832
    v_mfma_f32_16x16x32_bf16 v[56:59], v[28:31], v[204:207], v[56:59]
    ds_read_b64_tr_b16 v[20:21], v2 offset:6208
    v_mfma_f32_16x16x32_bf16 v[56:59], v[24:27], v[196:199], v[56:59]
    ds_read_b64_tr_b16 v[22:23], v2 offset:6976
    s_waitcnt lgkmcnt(4)
    v_mfma_f32_16x16x32_bf16 v[60:63], v[8:11], v[196:199], v[60:63]
    ds_read_b64_tr_b16 v[24:25], v3 offset:64
    v_mfma_f32_16x16x32_bf16 v[60:63], v[12:15], v[204:207], v[60:63]
    ds_read_b64_tr_b16 v[26:27], v3 offset:832
    v_mfma_f32_16x16x32_bf16 v[52:55], v[12:15], v[200:203], v[52:55]
    ds_read_b64_tr_b16 v[28:29], v3 offset:6208
    v_mfma_f32_16x16x32_bf16 v[52:55], v[8:11], v[192:195], v[52:55]
    ds_read_b64_tr_b16 v[30:31], v3 offset:6976
    s_waitcnt lgkmcnt(4)
    v_mfma_f32_16x16x32_bf16 v[64:67], v[16:19], v[192:195], v[64:67]
    ds_read_b64_tr_b16 v[8:9], v2 offset:12352
    v_mfma_f32_16x16x32_bf16 v[64:67], v[20:23], v[200:203], v[64:67]
    ds_read_b64_tr_b16 v[10:11], v2 offset:13120
    v_mfma_f32_16x16x32_bf16 v[72:75], v[20:23], v[204:207], v[72:75]
    ds_read_b64_tr_b16 v[12:13], v2 offset:18496
    v_mfma_f32_16x16x32_bf16 v[72:75], v[16:19], v[196:199], v[72:75]
    ds_read_b64_tr_b16 v[14:15], v2 offset:19264
    s_waitcnt lgkmcnt(4)
    v_mfma_f32_16x16x32_bf16 v[76:79], v[24:27], v[196:199], v[76:79]
    ds_read_b64_tr_b16 v[16:17], v3 offset:12352
    v_mfma_f32_16x16x32_bf16 v[76:79], v[28:31], v[204:207], v[76:79]
    ds_read_b64_tr_b16 v[18:19], v3 offset:13120
    v_mfma_f32_16x16x32_bf16 v[68:71], v[28:31], v[200:203], v[68:71]
    ds_read_b64_tr_b16 v[20:21], v3 offset:18496
    v_mfma_f32_16x16x32_bf16 v[68:71], v[24:27], v[192:195], v[68:71]
    ds_read_b64_tr_b16 v[22:23], v3 offset:19264
    s_waitcnt lgkmcnt(4)
    v_mfma_f32_16x16x32_bf16 v[80:83], v[8:11], v[192:195], v[80:83]
    ds_read_b64_tr_b16 v[24:25], v2 offset:128
    v_mfma_f32_16x16x32_bf16 v[80:83], v[12:15], v[200:203], v[80:83]
    ds_read_b64_tr_b16 v[26:27], v2 offset:896
    v_mfma_f32_16x16x32_bf16 v[88:91], v[12:15], v[204:207], v[88:91]
    ds_read_b64_tr_b16 v[28:29], v2 offset:6272
    v_mfma_f32_16x16x32_bf16 v[88:91], v[8:11], v[196:199], v[88:91]
    ds_read_b64_tr_b16 v[30:31], v2 offset:7040
    s_waitcnt lgkmcnt(4)
    v_mfma_f32_16x16x32_bf16 v[92:95], v[16:19], v[196:199], v[92:95]
    ds_read_b64_tr_b16 v[8:9], v3 offset:128
    v_mfma_f32_16x16x32_bf16 v[92:95], v[20:23], v[204:207], v[92:95]
    ds_read_b64_tr_b16 v[10:11], v3 offset:896
    v_mfma_f32_16x16x32_bf16 v[84:87], v[20:23], v[200:203], v[84:87]
    ds_read_b64_tr_b16 v[12:13], v3 offset:6272
    v_mfma_f32_16x16x32_bf16 v[84:87], v[16:19], v[192:195], v[84:87]
    ds_read_b64_tr_b16 v[14:15], v3 offset:7040
    s_waitcnt lgkmcnt(4)
    v_mfma_f32_16x16x32_bf16 v[96:99], v[24:27], v[192:195], v[96:99]
    ds_read_b64_tr_b16 v[16:17], v2 offset:12416
    v_mfma_f32_16x16x32_bf16 v[96:99], v[28:31], v[200:203], v[96:99]
    ds_read_b64_tr_b16 v[18:19], v2 offset:13184
    v_mfma_f32_16x16x32_bf16 v[104:107], v[28:31], v[204:207], v[104:107]
    ds_read_b64_tr_b16 v[20:21], v2 offset:18560
    v_mfma_f32_16x16x32_bf16 v[104:107], v[24:27], v[196:199], v[104:107]
    ds_read_b64_tr_b16 v[22:23], v2 offset:19328
    s_waitcnt lgkmcnt(4)
    v_mfma_f32_16x16x32_bf16 v[108:111], v[8:11], v[196:199], v[108:111]
    ds_read_b64_tr_b16 v[24:25], v3 offset:12416
    v_mfma_f32_16x16x32_bf16 v[108:111], v[12:15], v[204:207], v[108:111]
    ds_read_b64_tr_b16 v[26:27], v3 offset:13184
    v_mfma_f32_16x16x32_bf16 v[100:103], v[12:15], v[200:203], v[100:103]
    ds_read_b64_tr_b16 v[28:29], v3 offset:18560
    v_mfma_f32_16x16x32_bf16 v[100:103], v[8:11], v[192:195], v[100:103]
    ds_read_b64_tr_b16 v[30:31], v3 offset:19328
    s_waitcnt lgkmcnt(4)
    v_mfma_f32_16x16x32_bf16 v[112:115], v[16:19], v[192:195], v[112:115]
    s_barrier
    ds_read_b64_tr_b16 v[8:9], v2 offset:24576
    v_mfma_f32_16x16x32_bf16 v[112:115], v[20:23], v[200:203], v[112:115]
    ds_read_b64_tr_b16 v[10:11], v2 offset:25344
    v_mfma_f32_16x16x32_bf16 v[120:123], v[20:23], v[204:207], v[120:123]
    ds_read_b64_tr_b16 v[12:13], v2 offset:30720
    v_mfma_f32_16x16x32_bf16 v[120:123], v[16:19], v[196:199], v[120:123]
    ds_read_b64_tr_b16 v[14:15], v2 offset:31488
    s_waitcnt lgkmcnt(4)
    v_mfma_f32_16x16x32_bf16 v[124:127], v[24:27], v[196:199], v[124:127]
    ds_read_b64_tr_b16 v[16:17], v3 offset:24576
    v_mfma_f32_16x16x32_bf16 v[124:127], v[28:31], v[204:207], v[124:127]
    ds_read_b64_tr_b16 v[18:19], v3 offset:25344
    v_mfma_f32_16x16x32_bf16 v[116:119], v[28:31], v[200:203], v[116:119]
    ds_read_b64_tr_b16 v[20:21], v3 offset:30720
    v_mfma_f32_16x16x32_bf16 v[116:119], v[24:27], v[192:195], v[116:119]
    ds_read_b64_tr_b16 v[22:23], v3 offset:31488
    s_waitcnt lgkmcnt(4)
    v_mfma_f32_16x16x32_bf16 v[32:35], v[8:11], v[208:211], v[32:35]
    ds_read_b64_tr_b16 v[24:25], v2 offset:36864
    v_mfma_f32_16x16x32_bf16 v[32:35], v[12:15], v[216:219], v[32:35]
    ds_read_b64_tr_b16 v[26:27], v2 offset:37632
    v_mfma_f32_16x16x32_bf16 v[40:43], v[12:15], v[220:223], v[40:43]
    ds_read_b64_tr_b16 v[28:29], v2 offset:43008
    v_mfma_f32_16x16x32_bf16 v[40:43], v[8:11], v[212:215], v[40:43]
    ds_read_b64_tr_b16 v[30:31], v2 offset:43776
    s_waitcnt lgkmcnt(4)
    v_mfma_f32_16x16x32_bf16 v[44:47], v[16:19], v[212:215], v[44:47]
    ds_read_b64_tr_b16 v[8:9], v3 offset:36864
    v_mfma_f32_16x16x32_bf16 v[44:47], v[20:23], v[220:223], v[44:47]
    ds_read_b64_tr_b16 v[10:11], v3 offset:37632
    v_mfma_f32_16x16x32_bf16 v[36:39], v[20:23], v[216:219], v[36:39]
    ds_read_b64_tr_b16 v[12:13], v3 offset:43008
    v_mfma_f32_16x16x32_bf16 v[36:39], v[16:19], v[208:211], v[36:39]
    ds_read_b64_tr_b16 v[14:15], v3 offset:43776
    s_waitcnt lgkmcnt(4)
    v_mfma_f32_16x16x32_bf16 v[48:51], v[24:27], v[208:211], v[48:51]
    ds_read_b64_tr_b16 v[16:17], v2 offset:24640
    v_mfma_f32_16x16x32_bf16 v[48:51], v[28:31], v[216:219], v[48:51]
    ds_read_b64_tr_b16 v[18:19], v2 offset:25408
    v_mfma_f32_16x16x32_bf16 v[56:59], v[28:31], v[220:223], v[56:59]
    ds_read_b64_tr_b16 v[20:21], v2 offset:30784
    v_mfma_f32_16x16x32_bf16 v[56:59], v[24:27], v[212:215], v[56:59]
    ds_read_b64_tr_b16 v[22:23], v2 offset:31552
    s_waitcnt lgkmcnt(4)
    v_mfma_f32_16x16x32_bf16 v[60:63], v[8:11], v[212:215], v[60:63]
    ds_read_b64_tr_b16 v[24:25], v3 offset:24640
    v_mfma_f32_16x16x32_bf16 v[60:63], v[12:15], v[220:223], v[60:63]
    ds_read_b64_tr_b16 v[26:27], v3 offset:25408
    v_mfma_f32_16x16x32_bf16 v[52:55], v[12:15], v[216:219], v[52:55]
    ds_read_b64_tr_b16 v[28:29], v3 offset:30784
    v_mfma_f32_16x16x32_bf16 v[52:55], v[8:11], v[208:211], v[52:55]
    ds_read_b64_tr_b16 v[30:31], v3 offset:31552
    s_waitcnt lgkmcnt(4)
    v_mfma_f32_16x16x32_bf16 v[64:67], v[16:19], v[208:211], v[64:67]
    ds_read_b64_tr_b16 v[8:9], v2 offset:36928
    v_mfma_f32_16x16x32_bf16 v[64:67], v[20:23], v[216:219], v[64:67]
    ds_read_b64_tr_b16 v[10:11], v2 offset:37696
    v_mfma_f32_16x16x32_bf16 v[72:75], v[20:23], v[220:223], v[72:75]
    ds_read_b64_tr_b16 v[12:13], v2 offset:43072
    v_mfma_f32_16x16x32_bf16 v[72:75], v[16:19], v[212:215], v[72:75]
    ds_read_b64_tr_b16 v[14:15], v2 offset:43840
    s_waitcnt lgkmcnt(4)
    v_mfma_f32_16x16x32_bf16 v[76:79], v[24:27], v[212:215], v[76:79]
    ds_read_b64_tr_b16 v[16:17], v3 offset:36928
    v_mfma_f32_16x16x32_bf16 v[76:79], v[28:31], v[220:223], v[76:79]
    ds_read_b64_tr_b16 v[18:19], v3 offset:37696
    v_mfma_f32_16x16x32_bf16 v[68:71], v[28:31], v[216:219], v[68:71]
    ds_read_b64_tr_b16 v[20:21], v3 offset:43072
    v_mfma_f32_16x16x32_bf16 v[68:71], v[24:27], v[208:211], v[68:71]
    ds_read_b64_tr_b16 v[22:23], v3 offset:43840
    s_waitcnt lgkmcnt(4)
    v_mfma_f32_16x16x32_bf16 v[80:83], v[8:11], v[208:211], v[80:83]
    ds_read_b64_tr_b16 v[24:25], v2 offset:24704
    v_mfma_f32_16x16x32_bf16 v[80:83], v[12:15], v[216:219], v[80:83]
    ds_read_b64_tr_b16 v[26:27], v2 offset:25472
    v_mfma_f32_16x16x32_bf16 v[88:91], v[12:15], v[220:223], v[88:91]
    ds_read_b64_tr_b16 v[28:29], v2 offset:30848
    v_mfma_f32_16x16x32_bf16 v[88:91], v[8:11], v[212:215], v[88:91]
    ds_read_b64_tr_b16 v[30:31], v2 offset:31616
    s_waitcnt lgkmcnt(4)
    v_mfma_f32_16x16x32_bf16 v[92:95], v[16:19], v[212:215], v[92:95]
    ds_read_b64_tr_b16 v[8:9], v3 offset:24704
    v_mfma_f32_16x16x32_bf16 v[92:95], v[20:23], v[220:223], v[92:95]
    ds_read_b64_tr_b16 v[10:11], v3 offset:25472
    v_mfma_f32_16x16x32_bf16 v[84:87], v[20:23], v[216:219], v[84:87]
    ds_read_b64_tr_b16 v[12:13], v3 offset:30848
    v_mfma_f32_16x16x32_bf16 v[84:87], v[16:19], v[208:211], v[84:87]
    ds_read_b64_tr_b16 v[14:15], v3 offset:31616
    s_waitcnt lgkmcnt(4)
    v_mfma_f32_16x16x32_bf16 v[96:99], v[24:27], v[208:211], v[96:99]
    ds_read_b64_tr_b16 v[16:17], v2 offset:36992
    v_mfma_f32_16x16x32_bf16 v[96:99], v[28:31], v[216:219], v[96:99]
    ds_read_b64_tr_b16 v[18:19], v2 offset:37760
    v_mfma_f32_16x16x32_bf16 v[104:107], v[28:31], v[220:223], v[104:107]
    ds_read_b64_tr_b16 v[20:21], v2 offset:43136
    v_mfma_f32_16x16x32_bf16 v[104:107], v[24:27], v[212:215], v[104:107]
    ds_read_b64_tr_b16 v[22:23], v2 offset:43904
    s_waitcnt lgkmcnt(4)
    v_mfma_f32_16x16x32_bf16 v[108:111], v[8:11], v[212:215], v[108:111]
    ds_read_b64_tr_b16 v[24:25], v3 offset:36992
    v_mfma_f32_16x16x32_bf16 v[108:111], v[12:15], v[220:223], v[108:111]
    ds_read_b64_tr_b16 v[26:27], v3 offset:37760
    v_mfma_f32_16x16x32_bf16 v[100:103], v[12:15], v[216:219], v[100:103]
    ds_read_b64_tr_b16 v[28:29], v3 offset:43136
    v_mfma_f32_16x16x32_bf16 v[100:103], v[8:11], v[208:211], v[100:103]
    ds_read_b64_tr_b16 v[30:31], v3 offset:43904
    s_waitcnt lgkmcnt(4)
    v_mfma_f32_16x16x32_bf16 v[112:115], v[16:19], v[208:211], v[112:115]
    s_barrier
    ds_read_b64_tr_b16 v[8:9], v4 offset:0
    v_mfma_f32_16x16x32_bf16 v[112:115], v[20:23], v[216:219], v[112:115]
    ds_read_b64_tr_b16 v[10:11], v4 offset:768
    v_mfma_f32_16x16x32_bf16 v[120:123], v[20:23], v[220:223], v[120:123]
    ds_read_b64_tr_b16 v[12:13], v4 offset:6144
    v_mfma_f32_16x16x32_bf16 v[120:123], v[16:19], v[212:215], v[120:123]
    ds_read_b64_tr_b16 v[14:15], v4 offset:6912
    s_waitcnt lgkmcnt(4)
    v_mfma_f32_16x16x32_bf16 v[124:127], v[24:27], v[212:215], v[124:127]
    ds_read_b64_tr_b16 v[16:17], v5 offset:0
    v_mfma_f32_16x16x32_bf16 v[124:127], v[28:31], v[220:223], v[124:127]
    ds_read_b64_tr_b16 v[18:19], v5 offset:768
    v_mfma_f32_16x16x32_bf16 v[116:119], v[28:31], v[216:219], v[116:119]
    ds_read_b64_tr_b16 v[20:21], v5 offset:6144
    v_mfma_f32_16x16x32_bf16 v[116:119], v[24:27], v[208:211], v[116:119]
    ds_read_b64_tr_b16 v[22:23], v5 offset:6912
    s_waitcnt lgkmcnt(4)
    v_mfma_f32_16x16x32_bf16 v[32:35], v[8:11], v[224:227], v[32:35]
    ds_read_b64_tr_b16 v[24:25], v4 offset:12288
    v_mfma_f32_16x16x32_bf16 v[32:35], v[12:15], v[232:235], v[32:35]
    ds_read_b64_tr_b16 v[26:27], v4 offset:13056
    v_mfma_f32_16x16x32_bf16 v[40:43], v[12:15], v[236:239], v[40:43]
    ds_read_b64_tr_b16 v[28:29], v4 offset:18432
    v_mfma_f32_16x16x32_bf16 v[40:43], v[8:11], v[228:231], v[40:43]
    ds_read_b64_tr_b16 v[30:31], v4 offset:19200
    s_waitcnt lgkmcnt(4)
    v_mfma_f32_16x16x32_bf16 v[44:47], v[16:19], v[228:231], v[44:47]
    ds_read_b64_tr_b16 v[8:9], v5 offset:12288
    v_mfma_f32_16x16x32_bf16 v[44:47], v[20:23], v[236:239], v[44:47]
    ds_read_b64_tr_b16 v[10:11], v5 offset:13056
    v_mfma_f32_16x16x32_bf16 v[36:39], v[20:23], v[232:235], v[36:39]
    ds_read_b64_tr_b16 v[12:13], v5 offset:18432
    v_mfma_f32_16x16x32_bf16 v[36:39], v[16:19], v[224:227], v[36:39]
    ds_read_b64_tr_b16 v[14:15], v5 offset:19200
    s_waitcnt lgkmcnt(4)
    v_mfma_f32_16x16x32_bf16 v[48:51], v[24:27], v[224:227], v[48:51]
    s_barrier
    ds_read_b64_tr_b16 v[16:17], v4 offset:24576
    v_mfma_f32_16x16x32_bf16 v[48:51], v[28:31], v[232:235], v[48:51]
    ds_read_b64_tr_b16 v[18:19], v4 offset:25344
    v_mfma_f32_16x16x32_bf16 v[56:59], v[28:31], v[236:239], v[56:59]
    ds_read_b64_tr_b16 v[20:21], v4 offset:30720
    v_mfma_f32_16x16x32_bf16 v[56:59], v[24:27], v[228:231], v[56:59]
    ds_read_b64_tr_b16 v[22:23], v4 offset:31488
    s_waitcnt lgkmcnt(4)
    v_mfma_f32_16x16x32_bf16 v[60:63], v[8:11], v[228:231], v[60:63]
    ds_read_b64_tr_b16 v[24:25], v5 offset:24576
    v_mfma_f32_16x16x32_bf16 v[60:63], v[12:15], v[236:239], v[60:63]
    ds_read_b64_tr_b16 v[26:27], v5 offset:25344
    v_mfma_f32_16x16x32_bf16 v[52:55], v[12:15], v[232:235], v[52:55]
    ds_read_b64_tr_b16 v[28:29], v5 offset:30720
    v_mfma_f32_16x16x32_bf16 v[52:55], v[8:11], v[224:227], v[52:55]
    ds_read_b64_tr_b16 v[30:31], v5 offset:31488
    s_waitcnt lgkmcnt(4)
    v_mfma_f32_16x16x32_bf16 v[32:35], v[16:19], v[240:243], v[32:35]
    ds_read_b64_tr_b16 v[8:9], v4 offset:36864
    v_mfma_f32_16x16x32_bf16 v[32:35], v[20:23], v[248:251], v[32:35]
    ds_read_b64_tr_b16 v[10:11], v4 offset:37632
    v_mfma_f32_16x16x32_bf16 v[40:43], v[20:23], v[252:255], v[40:43]
    ds_read_b64_tr_b16 v[12:13], v4 offset:43008
    v_mfma_f32_16x16x32_bf16 v[40:43], v[16:19], v[244:247], v[40:43]
    ds_read_b64_tr_b16 v[14:15], v4 offset:43776
    s_waitcnt lgkmcnt(4)
    v_mfma_f32_16x16x32_bf16 v[44:47], v[24:27], v[244:247], v[44:47]
    ds_read_b64_tr_b16 v[16:17], v5 offset:36864
    v_mfma_f32_16x16x32_bf16 v[44:47], v[28:31], v[252:255], v[44:47]
    ds_read_b64_tr_b16 v[18:19], v5 offset:37632
    v_mfma_f32_16x16x32_bf16 v[36:39], v[28:31], v[248:251], v[36:39]
    ds_read_b64_tr_b16 v[20:21], v5 offset:43008
    v_mfma_f32_16x16x32_bf16 v[36:39], v[24:27], v[240:243], v[36:39]
    ds_read_b64_tr_b16 v[22:23], v5 offset:43776
    s_waitcnt lgkmcnt(4)
    v_mfma_f32_16x16x32_bf16 v[48:51], v[8:11], v[240:243], v[48:51]
    ds_read_b64_tr_b16 v[24:25], v4 offset:64
    v_mfma_f32_16x16x32_bf16 v[48:51], v[12:15], v[248:251], v[48:51]
    ds_read_b64_tr_b16 v[26:27], v4 offset:832
    v_mfma_f32_16x16x32_bf16 v[56:59], v[12:15], v[252:255], v[56:59]
    ds_read_b64_tr_b16 v[28:29], v4 offset:6208
    v_mfma_f32_16x16x32_bf16 v[56:59], v[8:11], v[244:247], v[56:59]
    ds_read_b64_tr_b16 v[30:31], v4 offset:6976
    s_waitcnt lgkmcnt(4)
    v_mfma_f32_16x16x32_bf16 v[60:63], v[16:19], v[244:247], v[60:63]
    ds_read_b64_tr_b16 v[8:9], v5 offset:64
    v_mfma_f32_16x16x32_bf16 v[60:63], v[20:23], v[252:255], v[60:63]
    ds_read_b64_tr_b16 v[10:11], v5 offset:832
    v_mfma_f32_16x16x32_bf16 v[52:55], v[20:23], v[248:251], v[52:55]
    ds_read_b64_tr_b16 v[12:13], v5 offset:6208
    v_mfma_f32_16x16x32_bf16 v[52:55], v[16:19], v[240:243], v[52:55]
    ds_read_b64_tr_b16 v[14:15], v5 offset:6976
    s_setprio 1
    s_waitcnt lgkmcnt(4)
    v_mfma_f32_16x16x32_bf16 v[64:67], v[24:27], v[224:227], v[64:67]
    ds_read_b64_tr_b16 v[16:17], v4 offset:12352
    v_mfma_f32_16x16x32_bf16 v[64:67], v[28:31], v[232:235], v[64:67]
    ds_read_b64_tr_b16 v[18:19], v4 offset:13120
    v_mfma_f32_16x16x32_bf16 v[72:75], v[28:31], v[236:239], v[72:75]
    ds_read_b64_tr_b16 v[20:21], v4 offset:18496
    v_mfma_f32_16x16x32_bf16 v[72:75], v[24:27], v[228:231], v[72:75]
    ds_read_b64_tr_b16 v[22:23], v4 offset:19264
    v_mul_f32 v128, s80, v32
    v_mul_f32 v129, s80, v33
    v_mul_f32 v130, s80, v34
    v_mul_f32 v131, s80, v35
    s_waitcnt lgkmcnt(4)
    v_mfma_f32_16x16x32_bf16 v[76:79], v[8:11], v[228:231], v[76:79]
    ds_read_b64_tr_b16 v[24:25], v5 offset:12352
    v_exp_f32 v128, v128
    v_mul_f32 v48, v32, v48
    v_exp_f32 v129, v129
    v_mul_f32 v49, v33, v49
    v_mfma_f32_16x16x32_bf16 v[76:79], v[12:15], v[236:239], v[76:79]
    ds_read_b64_tr_b16 v[26:27], v5 offset:13120
    v_exp_f32 v130, v130
    v_mul_f32 v50, v34, v50
    v_exp_f32 v131, v131
    v_mfma_f32_16x16x32_bf16 v[68:71], v[12:15], v[232:235], v[68:71]
    ds_read_b64_tr_b16 v[28:29], v5 offset:18496
    v_mul_f32 v51, v35, v51
    v_add_f32 v128, 1.0, v128
    v_add_f32 v129, 1.0, v129
    v_add_f32 v130, 1.0, v130
    v_mfma_f32_16x16x32_bf16 v[68:71], v[8:11], v[224:227], v[68:71]
    ds_read_b64_tr_b16 v[30:31], v5 offset:19264
    v_add_f32 v131, 1.0, v131
    v_rcp_f32 v128, v128
    v_rcp_f32 v129, v129
    v_rcp_f32 v130, v130
    s_waitcnt lgkmcnt(4)
    v_mfma_f32_16x16x32_bf16 v[80:83], v[16:19], v[224:227], v[80:83]
    ds_read_b64_tr_b16 v[8:9], v4 offset:24640
    v_rcp_f32 v131, v131
    v_mul_f32 v48, v128, v48
    v_mul_f32 v49, v129, v49
    v_mfma_f32_16x16x32_bf16 v[80:83], v[20:23], v[232:235], v[80:83]
    ds_read_b64_tr_b16 v[10:11], v4 offset:25408
    v_mul_f32 v50, v130, v50
    v_mul_f32 v51, v131, v51
    v_cvt_pk_bf16_f32 v136, v48, v49
    v_cvt_pk_bf16_f32 v137, v50, v51
    v_mfma_f32_16x16x32_bf16 v[88:91], v[20:23], v[236:239], v[88:91]
    ds_read_b64_tr_b16 v[12:13], v4 offset:30784
    v_mul_f32 v128, s80, v36
    v_mul_f32 v129, s80, v37
    v_mul_f32 v130, s80, v38
    v_mul_f32 v131, s80, v39
    v_mfma_f32_16x16x32_bf16 v[88:91], v[16:19], v[228:231], v[88:91]
    ds_read_b64_tr_b16 v[14:15], v4 offset:31552
    v_exp_f32 v128, v128
    v_mul_f32 v52, v36, v52
    v_exp_f32 v129, v129
    s_waitcnt lgkmcnt(4)
    v_mfma_f32_16x16x32_bf16 v[92:95], v[24:27], v[228:231], v[92:95]
    ds_read_b64_tr_b16 v[16:17], v5 offset:24640
    v_mul_f32 v53, v37, v53
    v_exp_f32 v130, v130
    v_mul_f32 v54, v38, v54
    v_exp_f32 v131, v131
    v_mfma_f32_16x16x32_bf16 v[92:95], v[28:31], v[236:239], v[92:95]
    ds_read_b64_tr_b16 v[18:19], v5 offset:25408
    v_mul_f32 v55, v39, v55
    v_add_f32 v128, 1.0, v128
    v_add_f32 v129, 1.0, v129
    v_add_f32 v130, 1.0, v130
    v_mfma_f32_16x16x32_bf16 v[84:87], v[28:31], v[232:235], v[84:87]
    ds_read_b64_tr_b16 v[20:21], v5 offset:30784
    v_add_f32 v131, 1.0, v131
    v_rcp_f32 v128, v128
    v_rcp_f32 v129, v129
    v_mfma_f32_16x16x32_bf16 v[84:87], v[24:27], v[224:227], v[84:87]
    ds_read_b64_tr_b16 v[22:23], v5 offset:31552
    v_rcp_f32 v130, v130
    v_rcp_f32 v131, v131
    v_mul_f32 v52, v128, v52
    v_mul_f32 v53, v129, v53
    s_waitcnt lgkmcnt(4)
    v_mfma_f32_16x16x32_bf16 v[64:67], v[8:11], v[240:243], v[64:67]
    ds_read_b64_tr_b16 v[24:25], v4 offset:36928
    v_mul_f32 v54, v130, v54
    v_mul_f32 v55, v131, v55
    v_cvt_pk_bf16_f32 v138, v52, v53
    v_cvt_pk_bf16_f32 v139, v54, v55
    v_mfma_f32_16x16x32_bf16 v[64:67], v[12:15], v[248:251], v[64:67]
    ds_read_b64_tr_b16 v[26:27], v4 offset:37696
    buffer_store_dwordx4 v[136:139], v1, s[44:47], s75 offen offset:0 sc1
    v_mul_f32 v128, s80, v40
    v_mul_f32 v129, s80, v41
    v_mfma_f32_16x16x32_bf16 v[72:75], v[12:15], v[252:255], v[72:75]
    ds_read_b64_tr_b16 v[28:29], v4 offset:43072
    v_mul_f32 v130, s80, v42
    v_mul_f32 v131, s80, v43
    v_exp_f32 v128, v128
    v_mul_f32 v56, v40, v56
    v_mfma_f32_16x16x32_bf16 v[72:75], v[8:11], v[244:247], v[72:75]
    ds_read_b64_tr_b16 v[30:31], v4 offset:43840
    v_exp_f32 v129, v129
    v_mul_f32 v57, v41, v57
    v_exp_f32 v130, v130
    v_mul_f32 v58, v42, v58
    s_waitcnt lgkmcnt(4)
    v_mfma_f32_16x16x32_bf16 v[76:79], v[16:19], v[244:247], v[76:79]
    ds_read_b64_tr_b16 v[8:9], v5 offset:36928
    v_exp_f32 v131, v131
    v_mul_f32 v59, v43, v59
    v_add_f32 v128, 1.0, v128
    v_mfma_f32_16x16x32_bf16 v[76:79], v[20:23], v[252:255], v[76:79]
    ds_read_b64_tr_b16 v[10:11], v5 offset:37696
    v_add_f32 v129, 1.0, v129
    v_add_f32 v130, 1.0, v130
    v_add_f32 v131, 1.0, v131
    v_rcp_f32 v128, v128
    v_mfma_f32_16x16x32_bf16 v[68:71], v[20:23], v[248:251], v[68:71]
    ds_read_b64_tr_b16 v[12:13], v5 offset:43072
    v_rcp_f32 v129, v129
    v_rcp_f32 v130, v130
    v_rcp_f32 v131, v131
    v_mul_f32 v56, v128, v56
    v_mfma_f32_16x16x32_bf16 v[68:71], v[16:19], v[240:243], v[68:71]
    ds_read_b64_tr_b16 v[14:15], v5 offset:43840
    v_mul_f32 v57, v129, v57
    v_mul_f32 v58, v130, v58
    v_mul_f32 v59, v131, v59
    s_waitcnt lgkmcnt(4)
    v_mfma_f32_16x16x32_bf16 v[80:83], v[24:27], v[240:243], v[80:83]
    ds_read_b64_tr_b16 v[16:17], v4 offset:128
    v_cvt_pk_bf16_f32 v140, v56, v57
    v_cvt_pk_bf16_f32 v141, v58, v59
    v_mul_f32 v128, s80, v44
    v_mul_f32 v129, s80, v45
    v_mfma_f32_16x16x32_bf16 v[80:83], v[28:31], v[248:251], v[80:83]
    ds_read_b64_tr_b16 v[18:19], v4 offset:896
    v_mul_f32 v130, s80, v46
    v_mul_f32 v131, s80, v47
    v_exp_f32 v128, v128
    v_mul_f32 v60, v44, v60
    v_mfma_f32_16x16x32_bf16 v[88:91], v[28:31], v[252:255], v[88:91]
    ds_read_b64_tr_b16 v[20:21], v4 offset:6272
    v_exp_f32 v129, v129
    v_mul_f32 v61, v45, v61
    v_exp_f32 v130, v130
    v_mfma_f32_16x16x32_bf16 v[88:91], v[24:27], v[244:247], v[88:91]
    ds_read_b64_tr_b16 v[22:23], v4 offset:7040
    v_mul_f32 v62, v46, v62
    v_exp_f32 v131, v131
    v_mul_f32 v63, v47, v63
    v_add_f32 v128, 1.0, v128
    s_waitcnt lgkmcnt(4)
    v_mfma_f32_16x16x32_bf16 v[92:95], v[8:11], v[244:247], v[92:95]
    ds_read_b64_tr_b16 v[24:25], v5 offset:128
    v_add_f32 v129, 1.0, v129
    v_add_f32 v130, 1.0, v130
    v_add_f32 v131, 1.0, v131
    v_rcp_f32 v128, v128
    v_mfma_f32_16x16x32_bf16 v[92:95], v[12:15], v[252:255], v[92:95]
    ds_read_b64_tr_b16 v[26:27], v5 offset:896
    v_rcp_f32 v129, v129
    v_rcp_f32 v130, v130
    v_rcp_f32 v131, v131
    v_mfma_f32_16x16x32_bf16 v[84:87], v[12:15], v[248:251], v[84:87]
    ds_read_b64_tr_b16 v[28:29], v5 offset:6272
    v_mul_f32 v60, v128, v60
    v_mul_f32 v61, v129, v61
    v_mul_f32 v62, v130, v62
    v_mul_f32 v63, v131, v63
    v_mfma_f32_16x16x32_bf16 v[84:87], v[8:11], v[240:243], v[84:87]
    ds_read_b64_tr_b16 v[30:31], v5 offset:7040
    v_cvt_pk_bf16_f32 v142, v60, v61
    v_cvt_pk_bf16_f32 v143, v62, v63
    buffer_store_dwordx4 v[140:143], v1, s[44:47], s75 offen offset:1024 sc1
    s_waitcnt lgkmcnt(4)
    v_mfma_f32_16x16x32_bf16 v[96:99], v[16:19], v[224:227], v[96:99]
    ds_read_b64_tr_b16 v[8:9], v4 offset:12416
    v_mfma_f32_16x16x32_bf16 v[96:99], v[20:23], v[232:235], v[96:99]
    ds_read_b64_tr_b16 v[10:11], v4 offset:13184
    v_mfma_f32_16x16x32_bf16 v[104:107], v[20:23], v[236:239], v[104:107]
    ds_read_b64_tr_b16 v[12:13], v4 offset:18560
    v_mfma_f32_16x16x32_bf16 v[104:107], v[16:19], v[228:231], v[104:107]
    ds_read_b64_tr_b16 v[14:15], v4 offset:19328
    v_mul_f32 v128, s80, v64
    v_mul_f32 v129, s80, v65
    v_mul_f32 v130, s80, v66
    v_mul_f32 v131, s80, v67
    s_waitcnt lgkmcnt(4)
    v_mfma_f32_16x16x32_bf16 v[108:111], v[24:27], v[228:231], v[108:111]
    ds_read_b64_tr_b16 v[16:17], v5 offset:12416
    v_exp_f32 v128, v128
    v_mul_f32 v80, v64, v80
    v_exp_f32 v129, v129
    v_mul_f32 v81, v65, v81
    v_mfma_f32_16x16x32_bf16 v[108:111], v[28:31], v[236:239], v[108:111]
    ds_read_b64_tr_b16 v[18:19], v5 offset:13184
    v_exp_f32 v130, v130
    v_mul_f32 v82, v66, v82
    v_exp_f32 v131, v131
    v_mfma_f32_16x16x32_bf16 v[100:103], v[28:31], v[232:235], v[100:103]
    ds_read_b64_tr_b16 v[20:21], v5 offset:18560
    v_mul_f32 v83, v67, v83
    v_add_f32 v128, 1.0, v128
    v_add_f32 v129, 1.0, v129
    v_add_f32 v130, 1.0, v130
    v_mfma_f32_16x16x32_bf16 v[100:103], v[24:27], v[224:227], v[100:103]
    ds_read_b64_tr_b16 v[22:23], v5 offset:19328
    v_add_f32 v131, 1.0, v131
    v_rcp_f32 v128, v128
    v_rcp_f32 v129, v129
    v_rcp_f32 v130, v130
    s_waitcnt lgkmcnt(4)
    v_mfma_f32_16x16x32_bf16 v[112:115], v[8:11], v[224:227], v[112:115]
    ds_read_b64_tr_b16 v[24:25], v4 offset:24704
    v_rcp_f32 v131, v131
    v_mul_f32 v80, v128, v80
    v_mul_f32 v81, v129, v81
    v_mfma_f32_16x16x32_bf16 v[112:115], v[12:15], v[232:235], v[112:115]
    ds_read_b64_tr_b16 v[26:27], v4 offset:25472
    v_mul_f32 v82, v130, v82
    v_mul_f32 v83, v131, v83
    v_cvt_pk_bf16_f32 v144, v80, v81
    v_cvt_pk_bf16_f32 v145, v82, v83
    v_mfma_f32_16x16x32_bf16 v[120:123], v[12:15], v[236:239], v[120:123]
    ds_read_b64_tr_b16 v[28:29], v4 offset:30848
    v_mul_f32 v128, s80, v68
    v_mul_f32 v129, s80, v69
    v_mul_f32 v130, s80, v70
    v_mul_f32 v131, s80, v71
    v_mfma_f32_16x16x32_bf16 v[120:123], v[8:11], v[228:231], v[120:123]
    ds_read_b64_tr_b16 v[30:31], v4 offset:31616
    v_exp_f32 v128, v128
    v_mul_f32 v84, v68, v84
    v_exp_f32 v129, v129
    s_waitcnt lgkmcnt(4)
    v_mfma_f32_16x16x32_bf16 v[124:127], v[16:19], v[228:231], v[124:127]
    ds_read_b64_tr_b16 v[8:9], v5 offset:24704
    v_mul_f32 v85, v69, v85
    v_exp_f32 v130, v130
    v_mul_f32 v86, v70, v86
    v_exp_f32 v131, v131
    v_mfma_f32_16x16x32_bf16 v[124:127], v[20:23], v[236:239], v[124:127]
    ds_read_b64_tr_b16 v[10:11], v5 offset:25472
    v_mul_f32 v87, v71, v87
    v_add_f32 v128, 1.0, v128
    v_add_f32 v129, 1.0, v129
    v_add_f32 v130, 1.0, v130
    v_mfma_f32_16x16x32_bf16 v[116:119], v[20:23], v[232:235], v[116:119]
    ds_read_b64_tr_b16 v[12:13], v5 offset:30848
    v_add_f32 v131, 1.0, v131
    v_rcp_f32 v128, v128
    v_rcp_f32 v129, v129
    v_mfma_f32_16x16x32_bf16 v[116:119], v[16:19], v[224:227], v[116:119]
    ds_read_b64_tr_b16 v[14:15], v5 offset:31616
    v_rcp_f32 v130, v130
    v_rcp_f32 v131, v131
    v_mul_f32 v84, v128, v84
    v_mul_f32 v85, v129, v85
    s_waitcnt lgkmcnt(4)
    v_mfma_f32_16x16x32_bf16 v[96:99], v[24:27], v[240:243], v[96:99]
    ds_read_b64_tr_b16 v[16:17], v4 offset:36992
    v_mul_f32 v86, v130, v86
    v_mul_f32 v87, v131, v87
    v_cvt_pk_bf16_f32 v146, v84, v85
    v_cvt_pk_bf16_f32 v147, v86, v87
    v_mfma_f32_16x16x32_bf16 v[96:99], v[28:31], v[248:251], v[96:99]
    ds_read_b64_tr_b16 v[18:19], v4 offset:37760
    buffer_store_dwordx4 v[144:147], v1, s[44:47], s75 offen offset:2048 sc1
    v_mul_f32 v128, s80, v72
    v_mul_f32 v129, s80, v73
    v_mfma_f32_16x16x32_bf16 v[104:107], v[28:31], v[252:255], v[104:107]
    ds_read_b64_tr_b16 v[20:21], v4 offset:43136
    v_mul_f32 v130, s80, v74
    v_mul_f32 v131, s80, v75
    v_exp_f32 v128, v128
    v_mul_f32 v88, v72, v88
    v_mfma_f32_16x16x32_bf16 v[104:107], v[24:27], v[244:247], v[104:107]
    ds_read_b64_tr_b16 v[22:23], v4 offset:43904
    v_exp_f32 v129, v129
    v_mul_f32 v89, v73, v89
    v_exp_f32 v130, v130
    v_mul_f32 v90, v74, v90
    s_waitcnt lgkmcnt(4)
    v_mfma_f32_16x16x32_bf16 v[108:111], v[8:11], v[244:247], v[108:111]
    ds_read_b64_tr_b16 v[24:25], v5 offset:36992
    v_exp_f32 v131, v131
    v_mul_f32 v91, v75, v91
    v_add_f32 v128, 1.0, v128
    v_mfma_f32_16x16x32_bf16 v[108:111], v[12:15], v[252:255], v[108:111]
    ds_read_b64_tr_b16 v[26:27], v5 offset:37760
    v_add_f32 v129, 1.0, v129
    v_add_f32 v130, 1.0, v130
    v_add_f32 v131, 1.0, v131
    v_rcp_f32 v128, v128
    v_mfma_f32_16x16x32_bf16 v[100:103], v[12:15], v[248:251], v[100:103]
    ds_read_b64_tr_b16 v[28:29], v5 offset:43136
    v_rcp_f32 v129, v129
    v_rcp_f32 v130, v130
    v_rcp_f32 v131, v131
    v_mul_f32 v88, v128, v88
    v_mfma_f32_16x16x32_bf16 v[100:103], v[8:11], v[240:243], v[100:103]
    ds_read_b64_tr_b16 v[30:31], v5 offset:43904
    s_mov_b64 exec, 1
    ds_add_u32 v7, v6 offset:60
    s_mov_b64 exec, -1
    v_mul_f32 v89, v129, v89
    v_mul_f32 v90, v130, v90
    v_mul_f32 v91, v131, v91
    s_waitcnt lgkmcnt(5)
    v_mfma_f32_16x16x32_bf16 v[112:115], v[16:19], v[240:243], v[112:115]
    v_cvt_pk_bf16_f32 v148, v88, v89
    v_cvt_pk_bf16_f32 v149, v90, v91
    v_mul_f32 v128, s80, v76
    v_mul_f32 v129, s80, v77
    v_mfma_f32_16x16x32_bf16 v[112:115], v[20:23], v[248:251], v[112:115]
    v_mul_f32 v130, s80, v78
    v_mul_f32 v131, s80, v79
    v_exp_f32 v128, v128
    v_mul_f32 v92, v76, v92
    v_mfma_f32_16x16x32_bf16 v[120:123], v[20:23], v[252:255], v[120:123]
    v_exp_f32 v129, v129
    v_mul_f32 v93, v77, v93
    v_exp_f32 v130, v130
    v_mfma_f32_16x16x32_bf16 v[120:123], v[16:19], v[244:247], v[120:123]
    v_mul_f32 v94, v78, v94
    v_exp_f32 v131, v131
    v_mul_f32 v95, v79, v95
    v_add_f32 v128, 1.0, v128
    s_waitcnt lgkmcnt(1)
    v_mfma_f32_16x16x32_bf16 v[124:127], v[24:27], v[244:247], v[124:127]
    v_add_f32 v129, 1.0, v129
    v_add_f32 v130, 1.0, v130
    v_add_f32 v131, 1.0, v131
    v_rcp_f32 v128, v128
    v_mfma_f32_16x16x32_bf16 v[124:127], v[28:31], v[252:255], v[124:127]
    v_rcp_f32 v129, v129
    v_rcp_f32 v130, v130
    v_rcp_f32 v131, v131
    v_mfma_f32_16x16x32_bf16 v[116:119], v[28:31], v[248:251], v[116:119]
    v_mul_f32 v92, v128, v92
    v_mul_f32 v93, v129, v93
    v_mul_f32 v94, v130, v94
    v_mul_f32 v95, v131, v95
    v_mfma_f32_16x16x32_bf16 v[116:119], v[24:27], v[240:243], v[116:119]
    v_cvt_pk_bf16_f32 v150, v92, v93
    v_cvt_pk_bf16_f32 v151, v94, v95
    buffer_store_dwordx4 v[148:151], v1, s[44:47], s75 offen offset:3072 sc1
    v_pk_mul_f32 v[128:129], v[96:97], s[80:81]
    v_pk_mul_f32 v[130:131], v[98:99], s[80:81]
    v_pk_mul_f32 v[132:133], v[100:101], s[80:81]
    v_pk_mul_f32 v[134:135], v[102:103], s[80:81]
    v_exp_f32 v128, v128
    v_exp_f32 v129, v129
    v_exp_f32 v130, v130
    v_exp_f32 v131, v131
    v_exp_f32 v132, v132
    v_exp_f32 v133, v133
    v_exp_f32 v134, v134
    v_exp_f32 v135, v135
    v_pk_add_f32 v[128:129], v[128:129], 1.0 op_sel_hi:[1,0]
    v_pk_add_f32 v[130:131], v[130:131], 1.0 op_sel_hi:[1,0]
    v_pk_add_f32 v[132:133], v[132:133], 1.0 op_sel_hi:[1,0]
    v_pk_add_f32 v[134:135], v[134:135], 1.0 op_sel_hi:[1,0]
    v_rcp_f32 v128, v128
    v_rcp_f32 v129, v129
    v_rcp_f32 v130, v130
    v_rcp_f32 v131, v131
    v_rcp_f32 v132, v132
    v_rcp_f32 v133, v133
    v_rcp_f32 v134, v134
    v_rcp_f32 v135, v135
    v_pk_mul_f32 v[96:97], v[96:97], v[128:129]
    v_pk_mul_f32 v[98:99], v[98:99], v[130:131]
    v_pk_mul_f32 v[100:101], v[100:101], v[132:133]
    v_pk_mul_f32 v[102:103], v[102:103], v[134:135]
    v_pk_mul_f32 v[112:113], v[96:97], v[112:113]
    v_pk_mul_f32 v[114:115], v[98:99], v[114:115]
    v_pk_mul_f32 v[116:117], v[100:101], v[116:117]
    v_pk_mul_f32 v[118:119], v[102:103], v[118:119]
    v_cvt_pk_bf16_f32 v152, v112, v113
    v_cvt_pk_bf16_f32 v153, v114, v115
    v_cvt_pk_bf16_f32 v154, v116, v117
    v_cvt_pk_bf16_f32 v155, v118, v119
    buffer_store_dwordx4 v[152:155], v1, s[44:47], s77 offen offset:0 sc1
    v_pk_mul_f32 v[128:129], v[104:105], s[80:81]
    v_pk_mul_f32 v[130:131], v[106:107], s[80:81]
    v_pk_mul_f32 v[132:133], v[108:109], s[80:81]
    v_pk_mul_f32 v[134:135], v[110:111], s[80:81]
    v_exp_f32 v128, v128
    v_exp_f32 v129, v129
    v_exp_f32 v130, v130
    v_exp_f32 v131, v131
    v_exp_f32 v132, v132
    v_exp_f32 v133, v133
    v_exp_f32 v134, v134
    v_exp_f32 v135, v135
    v_pk_add_f32 v[128:129], v[128:129], 1.0 op_sel_hi:[1,0]
    v_pk_add_f32 v[130:131], v[130:131], 1.0 op_sel_hi:[1,0]
    v_pk_add_f32 v[132:133], v[132:133], 1.0 op_sel_hi:[1,0]
    v_pk_add_f32 v[134:135], v[134:135], 1.0 op_sel_hi:[1,0]
    v_rcp_f32 v128, v128
    v_rcp_f32 v129, v129
    v_rcp_f32 v130, v130
    v_rcp_f32 v131, v131
    v_rcp_f32 v132, v132
    v_rcp_f32 v133, v133
    v_rcp_f32 v134, v134
    v_rcp_f32 v135, v135
    v_pk_mul_f32 v[104:105], v[104:105], v[128:129]
    v_pk_mul_f32 v[106:107], v[106:107], v[130:131]
    v_pk_mul_f32 v[108:109], v[108:109], v[132:133]
    v_pk_mul_f32 v[110:111], v[110:111], v[134:135]
    v_pk_mul_f32 v[120:121], v[104:105], v[120:121]
    v_pk_mul_f32 v[122:123], v[106:107], v[122:123]
    v_pk_mul_f32 v[124:125], v[108:109], v[124:125]
    v_pk_mul_f32 v[126:127], v[110:111], v[126:127]
    v_cvt_pk_bf16_f32 v156, v120, v121
    v_cvt_pk_bf16_f32 v157, v122, v123
    v_cvt_pk_bf16_f32 v158, v124, v125
    v_cvt_pk_bf16_f32 v159, v126, v127
    buffer_store_dwordx4 v[156:159], v1, s[44:47], s77 offen offset:1024 sc1
    s_setprio 0
    v_mov_b32 v23, s71
    v_lshrrev_b32 v20, 4, v0
    v_lshlrev_b32 v20, 1, v20
    v_and_b32 v21, 7, v0
    v_xor_b32 v20, v20, v21
    v_lshlrev_b32 v20, 4, v20
    v_lshrrev_b32 v21, 3, v0
    v_lshl_add_u32 v20, v21, 10, v20
    s_lshl_b32 s73, s70, 7
    v_add_u32 v18, s73, v20
    v_add_u32 v19, 7168, v18
    v_mov_b32 v22, 151552
    ds_read_b32 v24, v22 offset:60
    s_waitcnt lgkmcnt(0)
    v_cmp_ne_u32 vcc, 4, v24
    s_nop 1
    s_cbranch_vccnz L_spinB
L_spinB_out:
    s_add_u32 m0, s101, 49152
    s_add_u32 s86, s86, 16384
    s_cmp_eq_u32 s86, s88
    s_cselect_b32 s86, s87, s86
    buffer_load_dwordx4 v18, s[56:59], s86 offen offset:0 lds
    buffer_load_dwordx4 v19, s[56:59], s86 offen offset:1024 lds
    s_add_u32 m0, s101, 51200
    s_add_u32 s86, s86, 16384
    buffer_load_dwordx4 v18, s[56:59], s86 offen offset:0 lds
    buffer_load_dwordx4 v19, s[56:59], s86 offen offset:1024 lds
    s_add_u32 m0, s101, 53248
    s_add_u32 s86, s86, 16384
    s_cmp_eq_u32 s86, s88
    s_cselect_b32 s86, s87, s86
    buffer_load_dwordx4 v18, s[56:59], s86 offen offset:0 lds
    buffer_load_dwordx4 v19, s[56:59], s86 offen offset:1024 lds
    v_lshrrev_b32 v20, 2, v0
    v_lshlrev_b32 v20, 7, v20
    v_bfe_u32 v21, v0, 3, 2
    v_lshl_add_u32 v20, v21, 5, v20
    v_and_b32 v21, 3, v0
    v_lshl_add_u32 v20, v21, 3, v20
    v_add_u32 v2, s101, v20
    v_xor_b32 v3, 32, v2
    v_xor_b32 v4, 64, v2
    v_xor_b32 v5, 96, v2
    v_add_u32 v6, 49152, v2
    v_add_u32 v7, 49152, v3
    v_add_u32 v8, 49152, v4
    v_add_u32 v9, 49152, v5
    v_add_u32 v10, 98304, v2
    v_add_u32 v11, 98304, v3
    v_add_u32 v12, 98304, v4
    v_add_u32 v13, 98304, v5
    s_mul_i32 s73, s69, 176128
    v_add_u32 v14, s73, v1
    v_add_u32 v15, 88064, v14
    s_lshl2_add_u32 s73, s69, s65
    s_mul_i32 s73, s73, 64
    s_add_u32 s73, s73, 0xb24000
    v_mul_u32_u24 v20, 8, v0
    s_waitcnt vmcnt(6)
    s_mov_b64 exec, 1
    buffer_store_dword v23, off, s[44:47], s76 offset:0 sc1
    s_mov_b64 exec, -1
    s_add_u32 m0, s101, 73728
    s_add_u32 s86, s86, 16384
    buffer_load_dwordx4 v18, s[56:59], s86 offen offset:0 lds
    buffer_load_dwordx4 v19, s[56:59], s86 offen offset:1024 lds
    s_add_u32 m0, s101, 75776
    s_add_u32 s86, s86, 16384
    s_cmp_eq_u32 s86, s88
    s_cselect_b32 s86, s87, s86
    buffer_load_dwordx4 v18, s[56:59], s86 offen offset:0 lds
    buffer_load_dwordx4 v19, s[56:59], s86 offen offset:1024 lds
    s_add_u32 m0, s101, 77824
    s_add_u32 s86, s86, 16384
    buffer_load_dwordx4 v18, s[56:59], s86 offen offset:0 lds
    buffer_load_dwordx4 v19, s[56:59], s86 offen offset:1024 lds
    ds_read_b32 v24, v22 offset:68
    s_waitcnt lgkmcnt(0)
    v_cmp_ne_u32 vcc, 4, v24
    s_nop 1
    s_cbranch_vccnz L_spinB2
L_spinB2_out:
    s_add_u32 s86, s86, 16384
    s_cmp_eq_u32 s86, s88
    s_cselect_b32 s86, s87, s86
    ds_read_b64_tr_b16 v[128:129], v10 offset:24576
    ds_read_b64_tr_b16 v[132:133], v11 offset:24576
    ds_read_b64_tr_b16 v[136:137], v12 offset:24576
    ds_read_b64_tr_b16 v[140:141], v13 offset:24576
    ds_read_b64_tr_b16 v[130:131], v10 offset:26624
    ds_read_b64_tr_b16 v[134:135], v11 offset:26624
    ds_read_b64_tr_b16 v[138:139], v12 offset:26624
    ds_read_b64_tr_b16 v[142:143], v13 offset:26624
    ds_read_b64_tr_b16 v[144:145], v10 offset:28672
    ds_read_b64_tr_b16 v[148:149], v11 offset:28672
    ds_read_b64_tr_b16 v[152:153], v12 offset:28672
    ds_read_b64_tr_b16 v[156:157], v13 offset:28672
    s_add_u32 s86, s86, 16384
    ds_read_b64_tr_b16 v[146:147], v10 offset:4096
    ds_read_b64_tr_b16 v[150:151], v11 offset:4096
    ds_read_b64_tr_b16 v[154:155], v12 offset:4096
    ds_read_b64_tr_b16 v[158:159], v13 offset:4096
    s_waitcnt vmcnt(11)
    ds_read_b64_tr_b16 v[160:161], v6 offset:0
    ds_read_b64_tr_b16 v[164:165], v7 offset:0
    ds_read_b64_tr_b16 v[168:169], v8 offset:0
    ds_read_b64_tr_b16 v[172:173], v9 offset:0
    s_waitcnt vmcnt(9)
    ds_read_b64_tr_b16 v[162:163], v6 offset:2048
    ds_read_b64_tr_b16 v[166:167], v7 offset:2048
    ds_read_b64_tr_b16 v[170:171], v8 offset:2048
    ds_read_b64_tr_b16 v[174:175], v9 offset:2048
    s_add_u32 s86, s86, 16384
    s_cmp_eq_u32 s86, s88
    s_cselect_b32 s86, s87, s86
    s_waitcnt vmcnt(7)
    ds_read_b64_tr_b16 v[176:177], v6 offset:4096
    ds_read_b64_tr_b16 v[180:181], v7 offset:4096
    ds_read_b64_tr_b16 v[184:185], v8 offset:4096
    ds_read_b64_tr_b16 v[188:189], v9 offset:4096
    s_waitcnt vmcnt(4)
    ds_read_b64_tr_b16 v[178:179], v6 offset:24576
    ds_read_b64_tr_b16 v[182:183], v7 offset:24576
    ds_read_b64_tr_b16 v[186:187], v8 offset:24576
    ds_read_b64_tr_b16 v[190:191], v9 offset:24576
    s_waitcnt vmcnt(2)
    ds_read_b64_tr_b16 v[192:193], v6 offset:26624
    ds_read_b64_tr_b16 v[196:197], v7 offset:26624
    ds_read_b64_tr_b16 v[200:201], v8 offset:26624
    ds_read_b64_tr_b16 v[204:205], v9 offset:26624
    s_add_u32 s86, s86, 16384
    s_waitcnt vmcnt(0)
    ds_read_b64_tr_b16 v[194:195], v6 offset:28672
    ds_read_b64_tr_b16 v[198:199], v7 offset:28672
    ds_read_b64_tr_b16 v[202:203], v8 offset:28672
    ds_read_b64_tr_b16 v[206:207], v9 offset:28672
    s_add_u32 s86, s86, 16384
    s_cmp_eq_u32 s86, s88
    s_cselect_b32 s86, s87, s86
    ds_read_b64_tr_b16 v[32:33], v10 offset:0
    ds_read_b64_tr_b16 v[36:37], v11 offset:0
    ds_read_b64_tr_b16 v[40:41], v12 offset:0
    ds_read_b64_tr_b16 v[44:45], v13 offset:0
    s_waitcnt lgkmcnt(4)
    s_mov_b64 exec, 1
    buffer_load_dword off, s[56:59], s58 lds
    s_mov_b64 exec, -1
    s_add_u32 m0, s101, 24576
    s_add_u32 s86, s86, 16384
    buffer_load_dwordx4 v18, s[56:59], s86 offen offset:0 lds
    buffer_load_dwordx4 v19, s[56:59], s86 offen offset:1024 lds
    ds_read_b64_tr_b16 v[34:35], v10 offset:2048
    ds_read_b64_tr_b16 v[38:39], v11 offset:2048
    ds_read_b64_tr_b16 v[42:43], v12 offset:2048
    ds_read_b64_tr_b16 v[46:47], v13 offset:2048
    s_add_u32 m0, s101, 26624
    s_add_u32 s86, s86, 16384
    s_cmp_eq_u32 s86, s88
    s_cselect_b32 s86, s87, s86
    buffer_load_dwordx4 v18, s[56:59], s86 offen offset:0 lds
    buffer_load_dwordx4 v19, s[56:59], s86 offen offset:1024 lds
    ds_read_b64_tr_b16 v[48:49], v2 offset:0
    ds_read_b64_tr_b16 v[52:53], v3 offset:0
    ds_read_b64_tr_b16 v[56:57], v4 offset:0
    ds_read_b64_tr_b16 v[60:61], v5 offset:0
    s_add_u32 m0, s101, 28672
    s_add_u32 s86, s86, 16384
    buffer_load_dwordx4 v18, s[56:59], s86 offen offset:0 lds
    buffer_load_dwordx4 v19, s[56:59], s86 offen offset:1024 lds
    ds_read_b64_tr_b16 v[50:51], v2 offset:2048
    ds_read_b64_tr_b16 v[54:55], v3 offset:2048
    ds_read_b64_tr_b16 v[58:59], v4 offset:2048
    ds_read_b64_tr_b16 v[62:63], v5 offset:2048
    s_waitcnt vmcnt(6) lgkmcnt(8)
    s_barrier
    s_mov_b64 exec, 0xff
    buffer_load_dword v21, v20, s[44:47], s73 offen sc1
    s_mov_b64 exec, -1
    s_add_u32 m0, s101, 49152
    s_add_u32 s86, s86, 16384
    s_cmp_eq_u32 s86, s88
    s_cselect_b32 s86, s87, s86
    buffer_load_dwordx4 v18, s[56:59], s86 offen offset:0 lds
    buffer_load_dwordx4 v19, s[56:59], s86 offen offset:1024 lds
    s_add_u32 m0, s101, 51200
    s_add_u32 s86, s86, 16384
    buffer_load_dwordx4 v18, s[56:59], s86 offen offset:0 lds
    buffer_load_dwordx4 v19, s[56:59], s86 offen offset:1024 lds
    s_add_u32 m0, s101, 53248
    s_add_u32 s86, s86, 16384
    s_cmp_eq_u32 s86, s88
    s_cselect_b32 s86, s87, s86
    s_cmp_eq_u32 s65, 3
    s_cselect_b32 s86, 0x2000000, s86
    buffer_load_dwordx4 v18, s[56:59], s86 offen offset:0 lds
    buffer_load_dwordx4 v19, s[56:59], s86 offen offset:1024 lds
    s_waitcnt vmcnt(6)
    v_cmp_ne_u32 vcc, s71, v21
    s_nop 1
    s_and_b64 vcc, vcc, 0xff
    s_cbranch_scc1 L_pollA
L_pollA_out:
    s_setprio 0
    buffer_load_dwordx4 v[208:211], v14, s[44:47], s89 offen offset:0 sc1
    s_add_u32 s93, s89, 2048
    s_cmp_eq_u32 s93, s91
    s_cselect_b32 s93, s90, s93
    buffer_load_dwordx4 v[212:215], v14, s[44:47], s93 offen offset:0 sc1
    s_add_u32 m0, s101, 73728
    s_add_u32 s86, s86, 16384
    buffer_load_dwordx4 v18, s[56:59], s86 offen offset:0 lds
    buffer_load_dwordx4 v19, s[56:59], s86 offen offset:1024 lds
    buffer_load_dwordx4 v[216:219], v14, s[44:47], s89 offen offset:1024 sc1
    buffer_load_dwordx4 v[220:223], v14, s[44:47], s93 offen offset:1024 sc1
    buffer_load_dwordx4 v[224:227], v15, s[44:47], s89 offen offset:0 sc1
    buffer_load_dwordx4 v[228:231], v15, s[44:47], s93 offen offset:0 sc1
    buffer_load_dwordx4 v[232:235], v15, s[44:47], s89 offen offset:1024 sc1
    buffer_load_dwordx4 v[236:239], v15, s[44:47], s93 offen offset:1024 sc1
    s_add_u32 s94, s93, 2048
    s_cmp_eq_u32 s94, s91
    s_cselect_b32 s94, s90, s94
    buffer_load_dwordx4 v[240:243], v14, s[44:47], s94 offen offset:0 sc1
    s_add_u32 s95, s94, 2048
    s_cmp_eq_u32 s95, s91
    s_cselect_b32 s95, s90, s95
    buffer_load_dwordx4 v[244:247], v14, s[44:47], s95 offen offset:0 sc1
    buffer_load_dwordx4 v[248:251], v14, s[44:47], s94 offen offset:1024 sc1
    s_waitcnt vmcnt(11)
    v_mfma_f32_16x16x32_bf16 v[64:67], v[208:211], v[128:131], 0
    buffer_load_dwordx4 v[252:255], v14, s[44:47], s95 offen offset:1024 sc1
    v_mfma_f32_16x16x32_bf16 v[64:67], v[212:215], v[144:147], v[64:67]
    s_add_u32 s96, s95, 2048
    v_mfma_f32_16x16x32_bf16 v[68:71], v[212:215], v[148:151], 0
    s_cmp_eq_u32 s96, s91
    s_cselect_b32 s96, s90, s96
    v_mfma_f32_16x16x32_bf16 v[68:71], v[208:211], v[132:135], v[68:71]
    v_mfma_f32_16x16x32_bf16 v[72:75], v[208:211], v[136:139], 0
    v_mfma_f32_16x16x32_bf16 v[72:75], v[212:215], v[152:155], v[72:75]
    v_mfma_f32_16x16x32_bf16 v[76:79], v[212:215], v[156:159], 0
    v_mfma_f32_16x16x32_bf16 v[76:79], v[208:211], v[140:143], v[76:79]
    s_waitcnt vmcnt(8)
    v_mfma_f32_16x16x32_bf16 v[92:95], v[216:219], v[140:143], 0
    buffer_load_dwordx4 v[208:211], v15, s[44:47], s94 offen offset:0 sc1
    v_mfma_f32_16x16x32_bf16 v[92:95], v[220:223], v[156:159], v[92:95]
    v_mfma_f32_16x16x32_bf16 v[88:91], v[220:223], v[152:155], 0
    v_mfma_f32_16x16x32_bf16 v[88:91], v[216:219], v[136:139], v[88:91]
    v_mfma_f32_16x16x32_bf16 v[84:87], v[216:219], v[132:135], 0
    buffer_load_dwordx4 v[212:215], v15, s[44:47], s95 offen offset:0 sc1
    v_mfma_f32_16x16x32_bf16 v[84:87], v[220:223], v[148:151], v[84:87]
    v_mfma_f32_16x16x32_bf16 v[80:83], v[220:223], v[144:147], 0
    v_mfma_f32_16x16x32_bf16 v[80:83], v[216:219], v[128:131], v[80:83]
    s_waitcnt vmcnt(8)
    v_mfma_f32_16x16x32_bf16 v[96:99], v[224:227], v[128:131], 0
    buffer_load_dwordx4 v[216:219], v15, s[44:47], s94 offen offset:1024 sc1
    v_mfma_f32_16x16x32_bf16 v[96:99], v[228:231], v[144:147], v[96:99]
    v_mfma_f32_16x16x32_bf16 v[100:103], v[228:231], v[148:151], 0
    v_mfma_f32_16x16x32_bf16 v[100:103], v[224:227], v[132:135], v[100:103]
    v_mfma_f32_16x16x32_bf16 v[104:107], v[224:227], v[136:139], 0
    buffer_load_dwordx4 v[220:223], v15, s[44:47], s95 offen offset:1024 sc1
    v_mfma_f32_16x16x32_bf16 v[104:107], v[228:231], v[152:155], v[104:107]
    v_mfma_f32_16x16x32_bf16 v[108:111], v[228:231], v[156:159], 0
    v_mfma_f32_16x16x32_bf16 v[108:111], v[224:227], v[140:143], v[108:111]
    s_waitcnt vmcnt(8)
    v_mfma_f32_16x16x32_bf16 v[124:127], v[232:235], v[140:143], 0
    buffer_load_dwordx4 v[224:227], v14, s[44:47], s96 offen offset:0 sc1
    v_mfma_f32_16x16x32_bf16 v[124:127], v[236:239], v[156:159], v[124:127]
    s_add_u32 s92, s96, 2048
    v_mfma_f32_16x16x32_bf16 v[120:123], v[236:239], v[152:155], 0
    s_cmp_eq_u32 s92, s91
    s_cselect_b32 s92, s90, s92
    v_mfma_f32_16x16x32_bf16 v[120:123], v[232:235], v[136:139], v[120:123]
    v_mfma_f32_16x16x32_bf16 v[116:119], v[232:235], v[132:135], 0
    buffer_load_dwordx4 v[228:231], v14, s[44:47], s92 offen offset:0 sc1
    v_mfma_f32_16x16x32_bf16 v[116:119], v[236:239], v[148:151], v[116:119]
    s_add_u32 s93, s92, 2048
    v_mfma_f32_16x16x32_bf16 v[112:115], v[236:239], v[144:147], 0
    s_cmp_eq_u32 s93, s91
    s_cselect_b32 s93, s90, s93
    v_mfma_f32_16x16x32_bf16 v[112:115], v[232:235], v[128:131], v[112:115]
    s_waitcnt vmcnt(8)
    v_mfma_f32_16x16x32_bf16 v[64:67], v[240:243], v[160:163], v[64:67]
    buffer_load_dwordx4 v[232:235], v14, s[44:47], s96 offen offset:1024 sc1
    v_mfma_f32_16x16x32_bf16 v[64:67], v[244:247], v[176:179], v[64:67]
    v_mfma_f32_16x16x32_bf16 v[68:71], v[244:247], v[180:183], v[68:71]
    v_mfma_f32_16x16x32_bf16 v[68:71], v[240:243], v[164:167], v[68:71]
    v_mfma_f32_16x16x32_bf16 v[72:75], v[240:243], v[168:171], v[72:75]
    buffer_load_dwordx4 v[236:239], v14, s[44:47], s92 offen offset:1024 sc1
    v_mfma_f32_16x16x32_bf16 v[72:75], v[244:247], v[184:187], v[72:75]
    v_mfma_f32_16x16x32_bf16 v[76:79], v[244:247], v[188:191], v[76:79]
    v_mfma_f32_16x16x32_bf16 v[76:79], v[240:243], v[172:175], v[76:79]
    s_waitcnt vmcnt(8)
    v_mfma_f32_16x16x32_bf16 v[92:95], v[248:251], v[172:175], v[92:95]
    buffer_load_dwordx4 v[240:243], v15, s[44:47], s96 offen offset:0 sc1
    v_mfma_f32_16x16x32_bf16 v[92:95], v[252:255], v[188:191], v[92:95]
    v_mfma_f32_16x16x32_bf16 v[88:91], v[252:255], v[184:187], v[88:91]
    v_mfma_f32_16x16x32_bf16 v[88:91], v[248:251], v[168:171], v[88:91]
    v_mfma_f32_16x16x32_bf16 v[84:87], v[248:251], v[164:167], v[84:87]
    buffer_load_dwordx4 v[244:247], v15, s[44:47], s92 offen offset:0 sc1
    v_mfma_f32_16x16x32_bf16 v[84:87], v[252:255], v[180:183], v[84:87]
    v_mfma_f32_16x16x32_bf16 v[80:83], v[252:255], v[176:179], v[80:83]
    v_mfma_f32_16x16x32_bf16 v[80:83], v[248:251], v[160:163], v[80:83]
    s_waitcnt vmcnt(8)
    v_mfma_f32_16x16x32_bf16 v[96:99], v[208:211], v[160:163], v[96:99]
    buffer_load_dwordx4 v[248:251], v15, s[44:47], s96 offen offset:1024 sc1
    v_mfma_f32_16x16x32_bf16 v[96:99], v[212:215], v[176:179], v[96:99]
    v_mfma_f32_16x16x32_bf16 v[100:103], v[212:215], v[180:183], v[100:103]
    v_mfma_f32_16x16x32_bf16 v[100:103], v[208:211], v[164:167], v[100:103]
    v_mfma_f32_16x16x32_bf16 v[104:107], v[208:211], v[168:171], v[104:107]
    buffer_load_dwordx4 v[252:255], v15, s[44:47], s92 offen offset:1024 sc1
    v_mfma_f32_16x16x32_bf16 v[104:107], v[212:215], v[184:187], v[104:107]
    v_mfma_f32_16x16x32_bf16 v[108:111], v[212:215], v[188:191], v[108:111]
    v_mfma_f32_16x16x32_bf16 v[108:111], v[208:211], v[172:175], v[108:111]
    s_waitcnt vmcnt(8)
    v_mfma_f32_16x16x32_bf16 v[124:127], v[216:219], v[172:175], v[124:127]
    buffer_load_dwordx4 v[208:211], v14, s[44:47], s93 offen offset:0 sc1
    v_mfma_f32_16x16x32_bf16 v[124:127], v[220:223], v[188:191], v[124:127]
    s_add_u32 s94, s93, 2048
    v_mfma_f32_16x16x32_bf16 v[120:123], v[220:223], v[184:187], v[120:123]
    s_cmp_eq_u32 s94, s91
    s_cselect_b32 s94, s90, s94
    v_mfma_f32_16x16x32_bf16 v[120:123], v[216:219], v[168:171], v[120:123]
    v_mfma_f32_16x16x32_bf16 v[116:119], v[216:219], v[164:167], v[116:119]
    buffer_load_dwordx4 v[212:215], v14, s[44:47], s93 offen offset:1024 sc1
    v_mfma_f32_16x16x32_bf16 v[116:119], v[220:223], v[180:183], v[116:119]
    v_mfma_f32_16x16x32_bf16 v[112:115], v[220:223], v[176:179], v[112:115]
    v_mfma_f32_16x16x32_bf16 v[112:115], v[216:219], v[160:163], v[112:115]
    s_waitcnt vmcnt(8)
    v_mfma_f32_16x16x32_bf16 v[64:67], v[224:227], v[192:195], v[64:67]
    buffer_load_dwordx4 v[216:219], v15, s[44:47], s93 offen offset:0 sc1
    v_mfma_f32_16x16x32_bf16 v[64:67], v[228:231], v[32:35], v[64:67]
    ds_read_b64_tr_b16 v[128:129], v2 offset:4096
    v_mfma_f32_16x16x32_bf16 v[68:71], v[228:231], v[36:39], v[68:71]
    ds_read_b64_tr_b16 v[132:133], v3 offset:4096
    v_mfma_f32_16x16x32_bf16 v[68:71], v[224:227], v[196:199], v[68:71]
    ds_read_b64_tr_b16 v[136:137], v4 offset:4096
    v_mfma_f32_16x16x32_bf16 v[72:75], v[224:227], v[200:203], v[72:75]
    buffer_load_dwordx4 v[220:223], v15, s[44:47], s93 offen offset:1024 sc1
    v_mfma_f32_16x16x32_bf16 v[72:75], v[228:231], v[40:43], v[72:75]
    ds_read_b64_tr_b16 v[140:141], v5 offset:4096
    v_mfma_f32_16x16x32_bf16 v[76:79], v[228:231], v[44:47], v[76:79]
    ds_read_b64_tr_b16 v[130:131], v2 offset:24576
    v_mfma_f32_16x16x32_bf16 v[76:79], v[224:227], v[204:207], v[76:79]
    s_waitcnt vmcnt(8)
    v_mfma_f32_16x16x32_bf16 v[92:95], v[232:235], v[204:207], v[92:95]
    buffer_load_dwordx4 v[224:227], v14, s[44:47], s94 offen offset:0 sc1
    v_mfma_f32_16x16x32_bf16 v[92:95], v[236:239], v[44:47], v[92:95]
    s_add_u32 s95, s94, 2048
    v_mfma_f32_16x16x32_bf16 v[88:91], v[236:239], v[40:43], v[88:91]
    s_cmp_eq_u32 s95, s91
    s_cselect_b32 s95, s90, s95
    v_mfma_f32_16x16x32_bf16 v[88:91], v[232:235], v[200:203], v[88:91]
    ds_read_b64_tr_b16 v[134:135], v3 offset:24576
    v_mfma_f32_16x16x32_bf16 v[84:87], v[232:235], v[196:199], v[84:87]
    buffer_load_dwordx4 v[228:231], v14, s[44:47], s95 offen offset:0 sc1
    v_mfma_f32_16x16x32_bf16 v[84:87], v[236:239], v[36:39], v[84:87]
    s_add_u32 s96, s95, 2048
    v_mfma_f32_16x16x32_bf16 v[80:83], v[236:239], v[32:35], v[80:83]
    s_cmp_eq_u32 s96, s91
    s_cselect_b32 s96, s90, s96
    v_mfma_f32_16x16x32_bf16 v[80:83], v[232:235], v[192:195], v[80:83]
    s_waitcnt vmcnt(8)
    v_mfma_f32_16x16x32_bf16 v[96:99], v[240:243], v[192:195], v[96:99]
    buffer_load_dwordx4 v[232:235], v14, s[44:47], s96 offen offset:0 sc1
    v_mfma_f32_16x16x32_bf16 v[96:99], v[244:247], v[32:35], v[96:99]
    s_add_u32 s92, s96, 2048
    v_mfma_f32_16x16x32_bf16 v[100:103], v[244:247], v[36:39], v[100:103]
    s_cmp_eq_u32 s92, s91
    s_cselect_b32 s92, s90, s92
    v_mfma_f32_16x16x32_bf16 v[100:103], v[240:243], v[196:199], v[100:103]
    s_cmp_eq_u32 s65, 3
    s_cselect_b32 s92, 0x2000000, s92
    v_mfma_f32_16x16x32_bf16 v[104:107], v[240:243], v[200:203], v[104:107]
    buffer_load_dwordx4 v[236:239], v14, s[44:47], s92 offen offset:0 sc1
    v_mfma_f32_16x16x32_bf16 v[104:107], v[244:247], v[40:43], v[104:107]
    ds_read_b64_tr_b16 v[138:139], v4 offset:24576
    v_mfma_f32_16x16x32_bf16 v[108:111], v[244:247], v[44:47], v[108:111]
    ds_read_b64_tr_b16 v[142:143], v5 offset:24576
    v_mfma_f32_16x16x32_bf16 v[108:111], v[240:243], v[204:207], v[108:111]
    s_waitcnt vmcnt(8)
    v_mfma_f32_16x16x32_bf16 v[124:127], v[248:251], v[204:207], v[124:127]
    buffer_load_dwordx4 v[240:243], v14, s[44:47], s94 offen offset:1024 sc1
    v_mfma_f32_16x16x32_bf16 v[124:127], v[252:255], v[44:47], v[124:127]
    v_mfma_f32_16x16x32_bf16 v[120:123], v[252:255], v[40:43], v[120:123]
    v_mfma_f32_16x16x32_bf16 v[120:123], v[248:251], v[200:203], v[120:123]
    v_mfma_f32_16x16x32_bf16 v[116:119], v[248:251], v[196:199], v[116:119]
    buffer_load_dwordx4 v[244:247], v14, s[44:47], s95 offen offset:1024 sc1
    v_mfma_f32_16x16x32_bf16 v[116:119], v[252:255], v[36:39], v[116:119]
    v_mfma_f32_16x16x32_bf16 v[112:115], v[252:255], v[32:35], v[112:115]
    v_mfma_f32_16x16x32_bf16 v[112:115], v[248:251], v[192:195], v[112:115]
    s_waitcnt vmcnt(9) lgkmcnt(8)
    v_mfma_f32_16x16x32_bf16 v[64:67], v[208:211], v[48:51], v[64:67]
    buffer_load_dwordx4 v[248:251], v14, s[44:47], s96 offen offset:1024 sc1
    v_mfma_f32_16x16x32_bf16 v[68:71], v[208:211], v[52:55], v[68:71]
    ds_read_b64_tr_b16 v[144:145], v2 offset:26624
    v_mfma_f32_16x16x32_bf16 v[72:75], v[208:211], v[56:59], v[72:75]
    ds_read_b64_tr_b16 v[148:149], v3 offset:26624
    v_mfma_f32_16x16x32_bf16 v[76:79], v[208:211], v[60:63], v[76:79]
    s_waitcnt vmcnt(9)
    v_mfma_f32_16x16x32_bf16 v[92:95], v[212:215], v[60:63], v[92:95]
    buffer_load_dwordx4 v[252:255], v14, s[44:47], s92 offen offset:1024 sc1
    v_mfma_f32_16x16x32_bf16 v[88:91], v[212:215], v[56:59], v[88:91]
    ds_read_b64_tr_b16 v[152:153], v4 offset:26624
    v_mfma_f32_16x16x32_bf16 v[84:87], v[212:215], v[52:55], v[84:87]
    ds_read_b64_tr_b16 v[156:157], v5 offset:26624
    v_mfma_f32_16x16x32_bf16 v[80:83], v[212:215], v[48:51], v[80:83]
    s_waitcnt vmcnt(9)
    v_mfma_f32_16x16x32_bf16 v[96:99], v[216:219], v[48:51], v[96:99]
    buffer_load_dwordx4 v[208:211], v15, s[44:47], s94 offen offset:0 sc1
    v_mfma_f32_16x16x32_bf16 v[100:103], v[216:219], v[52:55], v[100:103]
    ds_read_b64_tr_b16 v[146:147], v2 offset:28672
    v_mfma_f32_16x16x32_bf16 v[104:107], v[216:219], v[56:59], v[104:107]
    ds_read_b64_tr_b16 v[150:151], v3 offset:28672
    v_mfma_f32_16x16x32_bf16 v[108:111], v[216:219], v[60:63], v[108:111]
    ds_read_b64_tr_b16 v[154:155], v4 offset:28672
    ds_read_b64_tr_b16 v[158:159], v5 offset:28672
    s_waitcnt vmcnt(9)
    v_mfma_f32_16x16x32_bf16 v[124:127], v[220:223], v[60:63], v[124:127]
    buffer_load_dwordx4 v[212:215], v15, s[44:47], s95 offen offset:0 sc1
    v_mfma_f32_16x16x32_bf16 v[120:123], v[220:223], v[56:59], v[120:123]
    ds_read_b64_tr_b16 v[160:161], v6 offset:0
    v_mfma_f32_16x16x32_bf16 v[116:119], v[220:223], v[52:55], v[116:119]
    ds_read_b64_tr_b16 v[164:165], v7 offset:0
    v_mfma_f32_16x16x32_bf16 v[112:115], v[220:223], v[48:51], v[112:115]
    ds_read_b64_tr_b16 v[168:169], v8 offset:0
    ds_read_b64_tr_b16 v[172:173], v9 offset:0
    ds_read_b64_tr_b16 v[162:163], v6 offset:2048
    ds_read_b64_tr_b16 v[166:167], v7 offset:2048
    ds_read_b64_tr_b16 v[170:171], v8 offset:2048
    ds_read_b64_tr_b16 v[174:175], v9 offset:2048
    ds_read_b64_tr_b16 v[176:177], v6 offset:4096
    ds_read_b64_tr_b16 v[180:181], v7 offset:4096
    ds_read_b64_tr_b16 v[184:185], v8 offset:4096
    ds_read_b64_tr_b16 v[188:189], v9 offset:4096
    ds_read_b64_tr_b16 v[178:179], v6 offset:24576
    ds_read_b64_tr_b16 v[182:183], v7 offset:24576
    ds_read_b64_tr_b16 v[186:187], v8 offset:24576
    ds_read_b64_tr_b16 v[190:191], v9 offset:24576
    s_waitcnt vmcnt(8) lgkmcnt(15)
    v_mfma_f32_16x16x32_bf16 v[64:67], v[224:227], v[128:131], v[64:67]
    buffer_load_dwordx4 v[216:219], v15, s[44:47], s96 offen offset:0 sc1
    v_mfma_f32_16x16x32_bf16 v[64:67], v[228:231], v[144:147], v[64:67]
    v_mfma_f32_16x16x32_bf16 v[68:71], v[228:231], v[148:151], v[68:71]
    v_mfma_f32_16x16x32_bf16 v[68:71], v[224:227], v[132:135], v[68:71]
    v_mfma_f32_16x16x32_bf16 v[72:75], v[224:227], v[136:139], v[72:75]
    buffer_load_dwordx4 v[220:223], v15, s[44:47], s92 offen offset:0 sc1
    v_mfma_f32_16x16x32_bf16 v[72:75], v[228:231], v[152:155], v[72:75]
    v_mfma_f32_16x16x32_bf16 v[76:79], v[228:231], v[156:159], v[76:79]
    v_mfma_f32_16x16x32_bf16 v[76:79], v[224:227], v[140:143], v[76:79]
    s_waitcnt vmcnt(8) lgkmcnt(0)
    v_mfma_f32_16x16x32_bf16 v[64:67], v[232:235], v[160:163], v[64:67]
    buffer_load_dwordx4 v[224:227], v15, s[44:47], s94 offen offset:1024 sc1
    v_mfma_f32_16x16x32_bf16 v[64:67], v[236:239], v[176:179], v[64:67]
    v_mfma_f32_16x16x32_bf16 v[68:71], v[236:239], v[180:183], v[68:71]
    v_mfma_f32_16x16x32_bf16 v[68:71], v[232:235], v[164:167], v[68:71]
    v_mfma_f32_16x16x32_bf16 v[72:75], v[232:235], v[168:171], v[72:75]
    buffer_load_dwordx4 v[228:231], v15, s[44:47], s95 offen offset:1024 sc1
    v_mfma_f32_16x16x32_bf16 v[72:75], v[236:239], v[184:187], v[72:75]
    v_mfma_f32_16x16x32_bf16 v[76:79], v[236:239], v[188:191], v[76:79]
    v_mfma_f32_16x16x32_bf16 v[76:79], v[232:235], v[172:175], v[76:79]
    s_waitcnt vmcnt(8)
    v_mfma_f32_16x16x32_bf16 v[80:83], v[240:243], v[128:131], v[80:83]
    buffer_load_dwordx4 v[232:235], v15, s[44:47], s96 offen offset:1024 sc1
    v_mfma_f32_16x16x32_bf16 v[80:83], v[244:247], v[144:147], v[80:83]
    v_mfma_f32_16x16x32_bf16 v[84:87], v[244:247], v[148:151], v[84:87]
    v_mfma_f32_16x16x32_bf16 v[84:87], v[240:243], v[132:135], v[84:87]
    s_add_u32 m0, s101, 0
    s_nop 0
    ds_write_addtid_b32 v64 offset:0
    v_mfma_f32_16x16x32_bf16 v[88:91], v[240:243], v[136:139], v[88:91]
    buffer_load_dwordx4 v[236:239], v15, s[44:47], s92 offen offset:1024 sc1
    v_mfma_f32_16x16x32_bf16 v[88:91], v[244:247], v[152:155], v[88:91]
    ds_write_addtid_b32 v65 offset:256
    v_mfma_f32_16x16x32_bf16 v[92:95], v[244:247], v[156:159], v[92:95]
    ds_write_addtid_b32 v66 offset:512
    v_mfma_f32_16x16x32_bf16 v[92:95], v[240:243], v[140:143], v[92:95]
    ds_write_addtid_b32 v67 offset:768
    s_waitcnt vmcnt(8)
    v_mfma_f32_16x16x32_bf16 v[80:83], v[248:251], v[160:163], v[80:83]
    ds_write_addtid_b32 v68 offset:1024
    v_mfma_f32_16x16x32_bf16 v[80:83], v[252:255], v[176:179], v[80:83]
    ds_write_addtid_b32 v69 offset:1280
    v_mfma_f32_16x16x32_bf16 v[84:87], v[252:255], v[180:183], v[84:87]
    ds_write_addtid_b32 v70 offset:1536
    v_mfma_f32_16x16x32_bf16 v[84:87], v[248:251], v[164:167], v[84:87]
    ds_write_addtid_b32 v71 offset:1792
    v_mfma_f32_16x16x32_bf16 v[88:91], v[248:251], v[168:171], v[88:91]
    ds_write_addtid_b32 v72 offset:2048
    v_mfma_f32_16x16x32_bf16 v[88:91], v[252:255], v[184:187], v[88:91]
    ds_write_addtid_b32 v73 offset:2304
    v_mfma_f32_16x16x32_bf16 v[92:95], v[252:255], v[188:191], v[92:95]
    ds_write_addtid_b32 v74 offset:2560
    v_mfma_f32_16x16x32_bf16 v[92:95], v[248:251], v[172:175], v[92:95]
    ds_write_addtid_b32 v75 offset:2816
    s_waitcnt vmcnt(6)
    v_mfma_f32_16x16x32_bf16 v[96:99], v[208:211], v[128:131], v[96:99]
    ds_write_addtid_b32 v76 offset:3072
    v_mfma_f32_16x16x32_bf16 v[96:99], v[212:215], v[144:147], v[96:99]
    ds_write_addtid_b32 v77 offset:3328
    v_mfma_f32_16x16x32_bf16 v[100:103], v[212:215], v[148:151], v[100:103]
    ds_write_addtid_b32 v78 offset:3584
    v_mfma_f32_16x16x32_bf16 v[100:103], v[208:211], v[132:135], v[100:103]
    ds_write_addtid_b32 v79 offset:3840
    v_mfma_f32_16x16x32_bf16 v[104:107], v[208:211], v[136:139], v[104:107]
    ds_write_addtid_b32 v80 offset:24576
    v_mfma_f32_16x16x32_bf16 v[104:107], v[212:215], v[152:155], v[104:107]
    ds_write_addtid_b32 v81 offset:24832
    s_waitcnt lgkmcnt(2)
    s_barrier
    v_mfma_f32_16x16x32_bf16 v[108:111], v[212:215], v[156:159], v[108:111]
    ds_write_addtid_b32 v82 offset:25088
    v_mfma_f32_16x16x32_bf16 v[108:111], v[208:211], v[140:143], v[108:111]
    ds_write_addtid_b32 v83 offset:25344
    s_waitcnt vmcnt(4)
    v_mfma_f32_16x16x32_bf16 v[96:99], v[216:219], v[160:163], v[96:99]
    ds_write_addtid_b32 v84 offset:25600
    v_mfma_f32_16x16x32_bf16 v[96:99], v[220:223], v[176:179], v[96:99]
    ds_write_addtid_b32 v85 offset:25856
    v_mfma_f32_16x16x32_bf16 v[100:103], v[220:223], v[180:183], v[100:103]
    ds_write_addtid_b32 v86 offset:26112
    v_mfma_f32_16x16x32_bf16 v[100:103], v[216:219], v[164:167], v[100:103]
    ds_write_addtid_b32 v87 offset:26368
    v_mfma_f32_16x16x32_bf16 v[104:107], v[216:219], v[168:171], v[104:107]
    ds_write_addtid_b32 v88 offset:26624
    v_mfma_f32_16x16x32_bf16 v[104:107], v[220:223], v[184:187], v[104:107]
    ds_write_addtid_b32 v89 offset:26880
    v_mfma_f32_16x16x32_bf16 v[108:111], v[220:223], v[188:191], v[108:111]
    ds_write_addtid_b32 v90 offset:27136
    v_mfma_f32_16x16x32_bf16 v[108:111], v[216:219], v[172:175], v[108:111]
    ds_write_addtid_b32 v91 offset:27392
    s_waitcnt vmcnt(2)
    v_mfma_f32_16x16x32_bf16 v[112:115], v[224:227], v[128:131], v[112:115]
    ds_write_addtid_b32 v92 offset:27648
    v_mfma_f32_16x16x32_bf16 v[112:115], v[228:231], v[144:147], v[112:115]
    ds_write_addtid_b32 v93 offset:27904
    v_mfma_f32_16x16x32_bf16 v[116:119], v[228:231], v[148:151], v[116:119]
    ds_write_addtid_b32 v94 offset:28160
    v_mfma_f32_16x16x32_bf16 v[116:119], v[224:227], v[132:135], v[116:119]
    ds_write_addtid_b32 v95 offset:28416
    v_mfma_f32_16x16x32_bf16 v[120:123], v[224:227], v[136:139], v[120:123]
    ds_write_addtid_b32 v96 offset:49152
    v_mfma_f32_16x16x32_bf16 v[120:123], v[228:231], v[152:155], v[120:123]
    ds_write_addtid_b32 v97 offset:49408
    s_waitcnt lgkmcnt(2)
    s_barrier
    v_mfma_f32_16x16x32_bf16 v[124:127], v[228:231], v[156:159], v[124:127]
    ds_write_addtid_b32 v98 offset:49664
    v_mfma_f32_16x16x32_bf16 v[124:127], v[224:227], v[140:143], v[124:127]
    ds_write_addtid_b32 v99 offset:49920
    s_waitcnt vmcnt(0)
    v_mfma_f32_16x16x32_bf16 v[112:115], v[232:235], v[160:163], v[112:115]
    ds_write_addtid_b32 v100 offset:50176
    v_mfma_f32_16x16x32_bf16 v[112:115], v[236:239], v[176:179], v[112:115]
    ds_write_addtid_b32 v101 offset:50432
    v_mfma_f32_16x16x32_bf16 v[116:119], v[236:239], v[180:183], v[116:119]
    ds_write_addtid_b32 v102 offset:50688
    v_mfma_f32_16x16x32_bf16 v[116:119], v[232:235], v[164:167], v[116:119]
    ds_write_addtid_b32 v103 offset:50944
    v_mfma_f32_16x16x32_bf16 v[120:123], v[232:235], v[168:171], v[120:123]
    ds_write_addtid_b32 v104 offset:51200
    v_mfma_f32_16x16x32_bf16 v[120:123], v[236:239], v[184:187], v[120:123]
    ds_write_addtid_b32 v105 offset:51456
    v_mfma_f32_16x16x32_bf16 v[124:127], v[236:239], v[188:191], v[124:127]
    ds_write_addtid_b32 v106 offset:51712
    v_mfma_f32_16x16x32_bf16 v[124:127], v[232:235], v[172:175], v[124:127]
    ds_write_addtid_b32 v107 offset:51968
    ds_write_addtid_b32 v108 offset:52224
    ds_write_addtid_b32 v109 offset:52480
    ds_write_addtid_b32 v110 offset:52736
    ds_write_addtid_b32 v111 offset:52992
    s_add_u32 m0, s101, 32768
    s_nop 0
    ds_write_addtid_b32 v112 offset:40960
    ds_write_addtid_b32 v113 offset:41216
    s_waitcnt lgkmcnt(2)
    s_barrier
    ds_write_addtid_b32 v114 offset:41472
    ds_write_addtid_b32 v115 offset:41728
    ds_write_addtid_b32 v116 offset:41984
    ds_write_addtid_b32 v117 offset:42240
    ds_write_addtid_b32 v118 offset:42496
    ds_write_addtid_b32 v119 offset:42752
    ds_write_addtid_b32 v120 offset:43008
    ds_write_addtid_b32 v121 offset:43264
    ds_write_addtid_b32 v122 offset:43520
    ds_write_addtid_b32 v123 offset:43776
    ds_write_addtid_b32 v124 offset:44032
    ds_write_addtid_b32 v125 offset:44288
    ds_write_addtid_b32 v126 offset:44544
    ds_write_addtid_b32 v127 offset:44800
    s_waitcnt lgkmcnt(0)
    s_barrier
    s_endpgm
L_spinB:
    s_mov_b32 s97, 0
L_spinB_l:
    s_sleep 1
    ds_read_b32 v24, v22 offset:60
    s_add_u32 s97, s97, 1
    s_cmp_gt_u32 s97, 4000000
    s_waitcnt lgkmcnt(0)
    s_cbranch_scc1 L_spinB_out
    v_cmp_ne_u32 vcc, 4, v24
    s_nop 1
    s_cbranch_vccnz L_spinB_l
    s_branch L_spinB_out
L_spinB2:
    s_mov_b32 s97, 0
L_spinB2_l:
    s_sleep 1
    ds_read_b32 v24, v22 offset:68
    s_add_u32 s97, s97, 1
    s_cmp_gt_u32 s97, 4000000
    s_waitcnt lgkmcnt(0)
    s_cbranch_scc1 L_spinB2_out
    v_cmp_ne_u32 vcc, 4, v24
    s_nop 1
    s_cbranch_vccnz L_spinB2_l
    s_branch L_spinB2_out
L_pollA:
    s_mov_b32 s97, 0
L_pollA_l:
    s_sleep 1
    s_mov_b64 exec, 0xff
    buffer_load_dword v21, v20, s[44:47], s73 offen sc1
    s_mov_b64 exec, -1
    s_add_u32 s97, s97, 1
    s_cmp_gt_u32 s97, 200000
    s_waitcnt vmcnt(0)
    s_cbranch_scc1 L_pollA_out
    v_cmp_ne_u32 vcc, s71, v21
    s_nop 1
    s_and_b64 vcc, vcc, 0xff
    s_cbranch_scc1 L_pollA_l
    s_branch L_pollA_out
.p2align 6
L_A:
    s_mul_i32 s72, s77, 11
    s_mul_i32 s78, s76, 3
    s_add_u32 s72, s72, s78
    s_cmp_eq_u32 s67, 15
    s_subb_u32 s72, s72, 0
    s_lshl_b32 s69, s77, 3
    s_add_u32 s69, s69, s75
    s_and_b32 s70, s73, 1
    s_lshl_b32 s70, s70, 2
    s_add_u32 s70, s70, s76
    v_lshlrev_b32 v1, 4, v0
    v_and_b32 v21, 3, v0
    v_bfe_u32 v22, v0, 2, 1
    v_lshl_add_u32 v21, v22, 3, v21
    v_bfe_u32 v22, v0, 3, 1
    v_lshl_add_u32 v21, v22, 2, v21
    s_and_b32 s81, s65, 1
    s_lshr_b32 s96, s65, 1
    s_lshl1_add_u32 s73, s67, s81
    s_lshl_b32 s73, s73, 5
    v_lshl_add_u32 v21, v21, 1, s73
    s_lshl_b32 s76, s66, 2
    s_add_u32 s76, s76, s65
    s_lshl_b32 s76, s76, 4
    s_add_u32 s76, s76, s67
    s_lshl_b32 s75, s76, 11
    v_lshrrev_b32 v4, 4, v0
    v_bfe_u32 v5, v0, 1, 3
    v_xor_b32 v4, v4, v5
    v_and_b32 v5, 15, v0
    v_lshlrev_b32 v5, 7, v5
    v_lshl_add_u32 v204, v4, 4, v5
    v_xor_b32 v205, 64, v204
    s_lshl_b32 s79, s76, 3
    s_add_u32 s79, s79, 0xb20000
    s_bfe_u32 s73, s67, 0x20001
    s_lshl_b32 s73, s73, 2
    s_lshr_b32 s74, s67, 3
    s_lshl_b32 s74, s74, 1
    s_add_u32 s73, s73, s74
    s_and_b32 s74, s67, 1
    s_add_u32 s73, s73, s74
    s_and_b32 s74, s73, 7
    s_lshl_b32 s73, s73, 8
    s_lshl_b32 s75, s65, 12
    s_add_u32 s73, s73, s75
    s_lshl_b32 s75, s81, 2
    s_xor_b32 s74, s74, s75
    v_and_b32 v4, 15, v0
    v_xor_b32 v4, s74, v4
    v_lshl_add_u32 v121, v4, 4, s73
    v_add_u32 v122, 49152, v121
    v_add_u32 v123, 98304, v121
    v_lshrrev_b32 v4, 4, v0
    v_add_u32 v4, s68, v4
    v_and_b32 v4, 7, v4
    v_and_b32 v5, 7, v0
    v_lshlrev_b32 v5, 4, v5
    v_lshl_add_u32 v124, v4, 7, v5
    v_xor_b32 v125, 0x200, v124
    v_bfe_u32 v4, v0, 3, 1
    v_lshlrev_b32 v126, 2, v4
    v_bfe_u32 v4, v0, 3, 1
    v_and_b32 v5, 3, v0
    v_lshl_add_u32 v4, v4, 2, v5
    v_lshrrev_b32 v5, 1, v4
    v_lshrrev_b32 v6, 4, v0
    v_xor_b32 v5, v5, v6
    v_and_b32 v6, 4, v0
    v_xor_b32 v5, v5, v6
    s_lshl_b32 s73, s96, 13
    s_lshl_b32 s74, s81, 11
    v_lshl_add_u32 v4, v4, 7, s73
    v_lshl_add_u32 v4, v6, 10, v4
    v_lshl_add_u32 v192, v5, 4, v4
    v_xor_b32 v193, 64, v192
    v_add_u32 v204, s74, v204
    v_add_u32 v194, 49152, v192
    v_add_u32 v206, 49152, v204
    v_add_u32 v196, 98304, v192
    v_add_u32 v208, 98304, v204
    v_add_u32 v205, s74, v205
    v_add_u32 v195, 49152, v193
    v_add_u32 v207, 49152, v205
    v_add_u32 v197, 98304, v193
    v_add_u32 v209, 98304, v205
    s_and_b32 s73, s67, 3
    s_cmp_eq_u32 s73, 3
    s_cselect_b32 s73, 14, s67
    s_cmp_eq_u32 s73, 14
    s_cselect_b32 s99, 8, 12
    s_and_b32 s74, s65, 1
    s_mul_i32 s73, s74, 88064
    s_lshl_b32 s74, s72, 6
    s_add_u32 s73, s73, s74
    v_add_u32 v25, 0, v0
    v_mul_u32_u24 v24, 171, v25
    v_lshrrev_b32 v24, 11, v24
    v_mul_u32_u24 v60, 12, v24
    v_sub_u32 v25, v25, v60
    v_cmp_gt_u32 vcc, s99, v25
    v_lshrrev_b32 v25, 3, v24
    v_lshlrev_b32 v25, 1, v25
    v_xor_b32 v25, v0, v25
    v_mul_u32_u24 v24, 2560, v24
    v_lshl_add_u32 v24, v25, 4, v24
    v_add_u32 v60, s73, v24
    v_mov_b32 v24, 0x2000000
    v_cndmask_b32 v60, v24, v60, vcc
    v_add_u32 v25, 64, v0
    v_mul_u32_u24 v24, 171, v25
    v_lshrrev_b32 v24, 11, v24
    v_mul_u32_u24 v61, 12, v24
    v_sub_u32 v25, v25, v61
    v_cmp_gt_u32 vcc, s99, v25
    v_lshrrev_b32 v25, 3, v24
    v_lshlrev_b32 v25, 1, v25
    v_xor_b32 v25, v0, v25
    v_mul_u32_u24 v24, 2560, v24
    v_lshl_add_u32 v24, v25, 4, v24
    v_add_u32 v61, s73, v24
    v_mov_b32 v24, 0x2000000
    v_cndmask_b32 v61, v24, v61, vcc
    v_add_u32 v25, 128, v0
    v_mul_u32_u24 v24, 171, v25
    v_lshrrev_b32 v24, 11, v24
    v_mul_u32_u24 v62, 12, v24
    v_sub_u32 v25, v25, v62
    v_cmp_gt_u32 vcc, s99, v25
    v_lshrrev_b32 v25, 3, v24
    v_lshlrev_b32 v25, 1, v25
    v_xor_b32 v25, v0, v25
    v_mul_u32_u24 v24, 2560, v24
    v_lshl_add_u32 v24, v25, 4, v24
    v_add_u32 v62, s73, v24
    v_mov_b32 v24, 0x2000000
    v_cndmask_b32 v62, v24, v62, vcc
    s_mul_i32 s101, s65, 6144
    v_lshrrev_b32 v24, 5, v0
    v_bfe_u32 v25, v0, 4, 1
    v_lshl_add_u32 v24, v25, 1, v24
    s_lshl_b32 s73, s96, 2
    v_add_u32 v3, s73, v24
    s_waitcnt lgkmcnt(0)
    s_mov_b32 s40, s4
    s_mov_b32 s41, s5
    s_mov_b32 s42, 0x200000
    s_mov_b32 s43, 0x20000
    s_mov_b32 s44, s36
    s_mov_b32 s45, s37
    s_mov_b32 s46, 0xb80000
    s_mov_b32 s47, 0x20000
    s_mov_b32 s77, 0xb48000
    s_lshl_b32 s73, s67, 6
    s_lshl_b32 s74, s81, 6
    s_add_u32 s74, s74, s77
    s_load_dword s3, s[36:37], s74
    s_load_dword s3, s[6:7], s73
    s_load_dword s3, s[8:9], s73
    s_load_dword s3, s[18:19], s73
    s_lshr_b32 s73, s2, 3
    s_lshl_b32 s73, s73, 2
    s_add_u32 s73, s73, s65
    s_and_b32 s73, s73, 15
    s_lshl_b32 s73, s73, 6
    s_load_dword s3, s[30:31], s73
    s_load_dword s3, s[20:21], s73
    s_lshl1_add_u32 s73, s2, s81
    s_min_u32 s73, s73, 383
    s_lshl_b32 s73, s73, 6
    s_add_u32 s73, s73, 0xb20000
    s_load_dword s3, s[36:37], s73
    s_mul_i32 s92, s70, 0
    s_add_u32 s92, s92, s69
    s_and_b32 s92, s92, 7
    s_and_b32 s80, s92, 1
    s_lshr_b32 s92, s92, 1
    s_bitcmp1_b32 s92, 0
    s_cselect_b32 s48, s16, s14
    s_cselect_b32 s49, s17, s15
    s_mov_b32 s50, 0x80000
    s_mov_b32 s51, 0x20000
    s_cselect_b32 s52, s14, s16
    s_cselect_b32 s53, s15, s17
    s_mov_b32 s54, 0x80000
    s_mov_b32 s55, 0x20000
    s_mov_b32 s56, s28
    s_mov_b32 s57, s29
    s_mov_b32 s58, 0x158000
    s_mov_b32 s59, 0x20000
    s_mul_i32 s93, s70, 0
    s_add_u32 s93, s93, s69
    s_and_b32 s93, s93, 7
    s_cmp_eq_u32 s65, 3
    s_cselect_b32 s95, 10, 11
    s_mul_i32 s93, s93, s95
    s_lshr_b32 s93, s93, 3
    s_mul_i32 s94, s65, 11
    s_add_u32 s93, s93, s94
    s_add_u32 s95, s95, s94
    s_lshl_b32 s93, s93, 15
    s_lshl_b32 s94, s94, 15
    s_lshl_b32 s95, s95, 15
    s_cmp_ge_u32 s65, 2
    s_cselect_b32 s60, s26, s24
    s_cselect_b32 s61, s27, s25
    s_mov_b32 s62, 0x158000
    s_mov_b32 s63, 0x20000
    s_lshl_b32 s73, s66, 2
    s_add_u32 s73, s73, s65
    s_mul_i32 s86, s73, 71424
    s_lshr_b32 s74, s67, 1
    s_lshl_b32 s74, s74, 13
    s_add_u32 s86, s86, s74
    s_mul_i32 s74, s81, 70912
    s_sub_u32 s86, s86, s74
    s_lshr_b32 s74, s67, 2
    s_mul_i32 s74, s74, 1280
    s_add_u32 s86, s86, s74
    s_and_b32 s74, s67, 1
    s_lshl_b32 s74, s74, 11
    s_add_u32 s86, s86, s74
    s_add_u32 s86, s86, 0x600000
    s_lshr_b32 s74, s73, 1
    s_lshl_b32 s74, s74, 4
    s_add_u32 s74, s74, s67
    s_lshl_b32 s74, s74, 1
    s_and_b32 s73, s73, 1
    s_add_u32 s74, s74, s73
    s_mul_i32 s74, s74, 8
    s_add_u32 s87, s74, 0xb22000
    s_lshl_b32 s91, s67, 13
    s_add_u32 s91, s91, 0xb00000
    s_lshl_b32 s90, s66, 9
    s_add_u32 s90, s90, s91
    s_cmp_eq_u32 s96, 0
    s_cselect_b32 s90, s90, 0x2000000
    s_sub_u32 s91, s91, 1024
    s_lshl_b32 s73, s81, 4
    v_and_b32 v6, 15, v0
    v_add_u32 v6, s73, v6
    v_lshlrev_b32 v120, 4, v6
    v_lshlrev_b32 v6, 3, v6
    v_add_u32 v119, 147456, v6
    v_lshl_add_u32 v118, v3, 8, v119
    v_and_b32 v4, 3, v0
    v_bfe_u32 v5, v0, 3, 2
    v_lshl_add_u32 v4, v5, 2, v4
    v_bfe_u32 v5, v0, 2, 1
    v_lshrrev_b32 v6, 5, v0
    v_xor_b32 v5, v5, v6
    v_lshl_add_u32 v4, v5, 4, v4
    v_and_b32 v5, 1, v0
    v_lshlrev_b32 v5, 4, v5
    v_mov_b32 v6, 0x3f80
    v_lshlrev_b32 v5, v5, v6
    v_lshrrev_b32 v4, 1, v4
    v_cmp_eq_u32 vcc, 0, v4
    s_nop 1
    v_cndmask_b32 v216, 0, v5, vcc
    v_cmp_eq_u32 vcc, 1, v4
    s_nop 1
    v_cndmask_b32 v217, 0, v5, vcc
    v_cmp_eq_u32 vcc, 2, v4
    s_nop 1
    v_cndmask_b32 v218, 0, v5, vcc
    v_cmp_eq_u32 vcc, 3, v4
    s_nop 1
    v_cndmask_b32 v219, 0, v5, vcc
    v_cmp_eq_u32 vcc, 4, v4
    s_nop 1
    v_cndmask_b32 v220, 0, v5, vcc
    v_cmp_eq_u32 vcc, 5, v4
    s_nop 1
    v_cndmask_b32 v221, 0, v5, vcc
    v_cmp_eq_u32 vcc, 6, v4
    s_nop 1
    v_cndmask_b32 v222, 0, v5, vcc
    v_cmp_eq_u32 vcc, 7, v4
    s_nop 1
    v_cndmask_b32 v223, 0, v5, vcc
    v_and_b32 v6, 7, v0
    v_lshrrev_b32 v7, 4, v0
    v_xor_b32 v6, v6, v7
    v_lshlrev_b32 v6, 4, v6
    v_lshrrev_b32 v7, 3, v0
    v_lshl_add_u32 v6, v7, 10, v6
    s_lshl_b32 s73, s70, 16
    s_lshl_b32 s74, s65, 8
    s_add_u32 s73, s73, s74
    v_add_u32 v96, s73, v6
    v_xor_b32 v7, 64, v96
    v_add_u32 v97, 7168, v7
    v_add_u32 v98, 14336, v96
    v_add_u32 v99, 21504, v7
    v_lshrrev_b32 v6, 4, v0
    v_bfe_u32 v7, v0, 1, 3
    v_xor_b32 v6, v6, v7
    v_and_b32 v7, 15, v0
    v_lshlrev_b32 v7, 7, v7
    v_lshl_add_u32 v100, v6, 4, v7
    v_xor_b32 v101, 64, v100
    v_add_u32 v100, s101, v100
    v_add_u32 v104, 98304, v100
    v_add_u32 v101, s101, v101
    v_add_u32 v105, 98304, v101
    v_and_b32 v6, 15, v0
    v_lshlrev_b32 v6, 4, v6
    v_bfe_u32 v7, v0, 4, 1
    v_lshl_add_u32 v6, v7, 10, v6
    v_lshrrev_b32 v7, 5, v0
    v_lshl_add_u32 v102, v7, 8, v6
    s_lshr_b32 s88, s92, 1
    s_lshl_b32 s88, s88, 7
    s_lshl_b32 s89, s80, 15
    s_add_u32 s88, s88, s89
    s_xor_b32 s89, s88, 128
    v_lshrrev_b32 v6, 4, v0
    v_lshlrev_b32 v6, 1, v6
    v_and_b32 v7, 7, v0
    v_xor_b32 v6, v6, v7
    v_lshlrev_b32 v6, 4, v6
    v_lshrrev_b32 v7, 3, v0
    v_lshl_add_u32 v6, v7, 10, v6
    s_lshl_b32 s73, s70, 7
    v_add_u32 v108, s73, v6
    v_add_u32 v109, 7168, v108
    s_lshl_b32 s73, s65, 2
    s_sub_u32 s73, s66, s73
    s_sub_u32 s73, s73, 1
    s_lshl_b32 s78, s65, 11
    v_lshrrev_b32 v6, 5, v0
    v_sub_u32 v7, s73, v6
    v_cmp_le_i32 vcc, 0, v7
    v_cmp_le_i32 s[84:85], 2, v7
    v_and_b32 v4, 0x1f0, v1
    v_lshl_add_u32 v7, v7, 9, v4
    v_add_u32 v7, 1024, v7
    v_subrev_u32 v5, 2048, v7
    v_mov_b32 v112, 0x2000000
    v_cndmask_b32 v110, v112, v7, vcc
    v_cndmask_b32 v111, v112, v5, s[84:85]
    v_lshrrev_b32 v6, 4, v0
    v_lshl_add_u32 v7, v6, 11, v120
    v_add_u32 v113, 155648, v7
    v_lshlrev_b32 v6, 2, v6
    v_sub_u32 v114, s66, v6
    v_med3_i32 v115, v114, 0, 4
    v_mov_b32 v116, 1
    v_mov_b32 v117, 151552
    s_barrier
    ds_read_b128 v[224:227], v208 offset:16384
    ds_read_b128 v[128:131], v196 offset:0
    ds_read_b128 v[228:231], v209 offset:16384
    ds_read_b128 v[132:135], v197 offset:0
    ds_read_b128 v[236:239], v209 offset:20480
    ds_read_b128 v[232:235], v208 offset:20480
    ds_read_b128 v[136:139], v197 offset:1024
    ds_read_b128 v[140:143], v196 offset:1024
    ds_read_b128 v[144:147], v196 offset:2048
    ds_read_b128 v[148:151], v197 offset:2048
    s_waitcnt lgkmcnt(6)
    v_mfma_f32_16x16x32_bf16 v[64:67], v[128:131], v[224:227], 0
    s_mov_b32 exec_lo, 0xffff
    s_mov_b32 exec_hi, 0x0
    ds_read_b128 v[36:39], v123 offset:0
    s_mov_b64 exec, -1
    v_mfma_f32_16x16x32_bf16 v[64:67], v[132:135], v[228:231], v[64:67]
    ds_read_b128 v[152:155], v197 offset:3072
    s_waitcnt lgkmcnt(6)
    v_mfma_f32_16x16x32_bf16 v[80:83], v[132:135], v[236:239], 0
    ds_read_b128 v[156:159], v196 offset:3072
    v_mfma_f32_16x16x32_bf16 v[80:83], v[128:131], v[232:235], v[80:83]
    s_waitcnt lgkmcnt(5)
    v_mfma_f32_16x16x32_bf16 v[84:87], v[136:139], v[232:235], 0
    s_barrier
    ds_read_b128 v[240:243], v208 offset:40960
    ds_read_b128 v[160:163], v196 offset:24576
    v_mfma_f32_16x16x32_bf16 v[84:87], v[140:143], v[236:239], v[84:87]
    ds_read_b128 v[244:247], v209 offset:40960
    ds_read_b128 v[164:167], v197 offset:24576
    v_mfma_f32_16x16x32_bf16 v[68:71], v[140:143], v[228:231], 0
    ds_read_b128 v[252:255], v209 offset:45056
    v_mfma_f32_16x16x32_bf16 v[68:71], v[136:139], v[224:227], v[68:71]
    ds_read_b128 v[248:251], v208 offset:45056
    buffer_load_dword v19, off, s[44:47], s77 sc1
    global_load_ushort v16, v21, s[6:7]
    global_load_ushort v17, v21, s[8:9]
    global_load_ushort v18, v21, s[18:19]
    s_waitcnt lgkmcnt(9)
    v_mfma_f32_16x16x32_bf16 v[72:75], v[144:147], v[224:227], 0
    ds_read_b128 v[168:171], v197 offset:25600
    v_mfma_f32_16x16x32_bf16 v[72:75], v[148:151], v[228:231], v[72:75]
    ds_read_b128 v[172:175], v196 offset:25600
    v_mfma_f32_16x16x32_bf16 v[88:91], v[148:151], v[236:239], 0
    v_mfma_f32_16x16x32_bf16 v[88:91], v[144:147], v[232:235], v[88:91]
    s_waitcnt lgkmcnt(8)
    v_mfma_f32_16x16x32_bf16 v[92:95], v[152:155], v[232:235], 0
    ds_read_b128 v[176:179], v196 offset:26624
    v_mfma_f32_16x16x32_bf16 v[92:95], v[156:159], v[236:239], v[92:95]
    ds_read_b128 v[180:183], v197 offset:26624
    v_mfma_f32_16x16x32_bf16 v[76:79], v[156:159], v[228:231], 0
    v_mfma_f32_16x16x32_bf16 v[76:79], v[152:155], v[224:227], v[76:79]
    s_waitcnt lgkmcnt(6)
    v_mfma_f32_16x16x32_bf16 v[64:67], v[160:163], v[240:243], v[64:67]
    s_mov_b32 exec_lo, 0xffff0000
    s_mov_b32 exec_hi, 0x0
    ds_read_b128 v[36:39], v123 offset:24576
    s_mov_b64 exec, -1
    v_mfma_f32_16x16x32_bf16 v[64:67], v[164:167], v[244:247], v[64:67]
    ds_read_b128 v[184:187], v197 offset:27648
    s_waitcnt lgkmcnt(6)
    v_mfma_f32_16x16x32_bf16 v[80:83], v[164:167], v[252:255], v[80:83]
    ds_read_b128 v[188:191], v196 offset:27648
    v_mfma_f32_16x16x32_bf16 v[80:83], v[160:163], v[248:251], v[80:83]
    s_waitcnt lgkmcnt(5)
    v_mfma_f32_16x16x32_bf16 v[84:87], v[168:171], v[248:251], v[84:87]
    s_barrier
    ds_read_b128 v[224:227], v204 offset:16384
    ds_read_b128 v[128:131], v192 offset:0
    v_mfma_f32_16x16x32_bf16 v[84:87], v[172:175], v[252:255], v[84:87]
    ds_read_b128 v[228:231], v205 offset:16384
    ds_read_b128 v[132:135], v193 offset:0
    v_mfma_f32_16x16x32_bf16 v[68:71], v[172:175], v[244:247], v[68:71]
    ds_read_b128 v[236:239], v205 offset:20480
    v_mfma_f32_16x16x32_bf16 v[68:71], v[168:171], v[240:243], v[68:71]
    ds_read_b128 v[232:235], v204 offset:20480
    s_waitcnt lgkmcnt(9)
    v_mfma_f32_16x16x32_bf16 v[72:75], v[176:179], v[240:243], v[72:75]
    ds_read_b128 v[136:139], v193 offset:1024
    v_mfma_f32_16x16x32_bf16 v[72:75], v[180:183], v[244:247], v[72:75]
    ds_read_b128 v[140:143], v192 offset:1024
    v_mfma_f32_16x16x32_bf16 v[88:91], v[180:183], v[252:255], v[88:91]
    v_mfma_f32_16x16x32_bf16 v[88:91], v[176:179], v[248:251], v[88:91]
    s_waitcnt lgkmcnt(8)
    v_mfma_f32_16x16x32_bf16 v[92:95], v[184:187], v[248:251], v[92:95]
    ds_read_b128 v[144:147], v192 offset:2048
    s_waitcnt vmcnt(0)
    v_mfma_f32_16x16x32_bf16 v[92:95], v[188:191], v[252:255], v[92:95]
    ds_read_b128 v[148:151], v193 offset:2048
    v_readfirstlane_b32 s71, v19
    v_mfma_f32_16x16x32_bf16 v[76:79], v[188:191], v[244:247], v[76:79]
    v_lshlrev_b32 v16, 16, v16
    v_mfma_f32_16x16x32_bf16 v[76:79], v[184:187], v[240:243], v[76:79]
    v_lshlrev_b32 v17, 16, v17
    s_waitcnt lgkmcnt(6)
    v_mfma_f32_16x16x32_bf16 v[64:67], v[128:131], v[224:227], v[64:67]
    s_mov_b32 exec_lo, 0x0
    s_mov_b32 exec_hi, 0xffff
    ds_read_b128 v[36:39], v121 offset:0
    s_mov_b64 exec, -1
    v_lshlrev_b32 v18, 16, v18
    v_mfma_f32_16x16x32_bf16 v[64:67], v[132:135], v[228:231], v[64:67]
    ds_read_b128 v[152:155], v193 offset:3072
    s_add_u32 s71, s71, 0x9e3779b8
    s_waitcnt lgkmcnt(6)
    v_mfma_f32_16x16x32_bf16 v[80:83], v[132:135], v[236:239], v[80:83]
    ds_read_b128 v[156:159], v192 offset:3072
    s_or_b32 s71, s71, 1
    v_mul_f32 v18, 0x3fb8aa3b, v18
    v_mfma_f32_16x16x32_bf16 v[80:83], v[128:131], v[232:235], v[80:83]
    v_exp_f32 v18, v18
    s_waitcnt lgkmcnt(5)
    v_mfma_f32_16x16x32_bf16 v[84:87], v[136:139], v[232:235], v[84:87]
    s_barrier
    ds_read_b128 v[240:243], v204 offset:40960
    ds_read_b128 v[160:163], v192 offset:24576
    v_mfma_f32_16x16x32_bf16 v[84:87], v[140:143], v[236:239], v[84:87]
    ds_read_b128 v[244:247], v205 offset:40960
    ds_read_b128 v[164:167], v193 offset:24576
    v_mfma_f32_16x16x32_bf16 v[68:71], v[140:143], v[228:231], v[68:71]
    ds_read_b128 v[252:255], v205 offset:45056
    v_cvt_pk_bf16_f32 v18, v18, v18
    v_lshlrev_b32 v18, 16, v18
    v_mul_f32 v21, v18, v16
    v_mfma_f32_16x16x32_bf16 v[68:71], v[136:139], v[224:227], v[68:71]
    ds_read_b128 v[248:251], v204 offset:45056
    v_mul_f32 v22, v18, v17
    s_waitcnt lgkmcnt(9)
    v_mfma_f32_16x16x32_bf16 v[72:75], v[144:147], v[224:227], v[72:75]
    ds_read_b128 v[168:171], v193 offset:25600
    v_mul_f32 v21, 0x3fb8aa3b, v21
    v_exp_f32 v21, v21
    v_mfma_f32_16x16x32_bf16 v[72:75], v[148:151], v[228:231], v[72:75]
    ds_read_b128 v[172:175], v192 offset:25600
    v_mul_f32 v22, 0.15915494, v22
    v_mfma_f32_16x16x32_bf16 v[88:91], v[148:151], v[236:239], v[88:91]
    v_rndne_f32 v23, v22
    v_mfma_f32_16x16x32_bf16 v[88:91], v[144:147], v[232:235], v[88:91]
    v_sub_f32 v22, v22, v23
    s_waitcnt lgkmcnt(8)
    v_mfma_f32_16x16x32_bf16 v[92:95], v[152:155], v[232:235], v[92:95]
    ds_read_b128 v[176:179], v192 offset:26624
    v_sin_f32 v23, v22
    v_mfma_f32_16x16x32_bf16 v[92:95], v[156:159], v[236:239], v[92:95]
    ds_read_b128 v[180:183], v193 offset:26624
    v_cos_f32 v22, v22
    v_mfma_f32_16x16x32_bf16 v[76:79], v[156:159], v[228:231], v[76:79]
    v_mul_f32 v49, v21, v23
    v_mfma_f32_16x16x32_bf16 v[76:79], v[152:155], v[224:227], v[76:79]
    v_mul_f32 v48, v21, v22
    v_mul_f32 v21, v16, v16
    s_waitcnt lgkmcnt(6)
    v_mfma_f32_16x16x32_bf16 v[64:67], v[160:163], v[240:243], v[64:67]
    s_mov_b32 exec_lo, 0x0
    s_mov_b32 exec_hi, 0xffff0000
    ds_read_b128 v[36:39], v121 offset:24576
    s_mov_b64 exec, -1
    v_fmac_f32 v21, v17, v17
    v_mfma_f32_16x16x32_bf16 v[64:67], v[164:167], v[244:247], v[64:67]
    ds_read_b128 v[184:187], v193 offset:27648
    v_rcp_f32 v21, v21
    s_waitcnt lgkmcnt(6)
    v_mfma_f32_16x16x32_bf16 v[80:83], v[164:167], v[252:255], v[80:83]
    ds_read_b128 v[188:191], v192 offset:27648
    v_add_f32 v22, -1.0, v48
    v_mfma_f32_16x16x32_bf16 v[80:83], v[160:163], v[248:251], v[80:83]
    v_add_f32 v21, v21, v21
    s_waitcnt lgkmcnt(5)
    v_mfma_f32_16x16x32_bf16 v[84:87], v[168:171], v[248:251], v[84:87]
    s_barrier
    ds_read_b128 v[224:227], v206 offset:16384
    ds_read_b128 v[128:131], v194 offset:0
    v_mfma_f32_16x16x32_bf16 v[84:87], v[172:175], v[252:255], v[84:87]
    ds_read_b128 v[228:231], v207 offset:16384
    ds_read_b128 v[132:135], v195 offset:0
    v_mfma_f32_16x16x32_bf16 v[68:71], v[172:175], v[244:247], v[68:71]
    ds_read_b128 v[236:239], v207 offset:20480
    v_mul_f32 v23, v22, v16
    v_fmac_f32 v23, v49, v17
    v_mul_f32 v58, v23, v21
    v_mul_f32 v23, v49, v16
    v_mfma_f32_16x16x32_bf16 v[68:71], v[168:171], v[240:243], v[68:71]
    ds_read_b128 v[232:235], v206 offset:20480
    v_fma_f32 v23, -v22, v17, v23
    s_waitcnt lgkmcnt(9)
    v_mfma_f32_16x16x32_bf16 v[72:75], v[176:179], v[240:243], v[72:75]
    ds_read_b128 v[136:139], v195 offset:1024
    v_mul_f32 v59, v23, v21
    v_mfma_f32_16x16x32_bf16 v[72:75], v[180:183], v[244:247], v[72:75]
    ds_read_b128 v[140:143], v194 offset:1024
    v_mul_f32 v30, v48, v48
    v_mfma_f32_16x16x32_bf16 v[88:91], v[180:183], v[252:255], v[88:91]
    v_mul_f32 v31, v48, v49
    v_mfma_f32_16x16x32_bf16 v[88:91], v[176:179], v[248:251], v[88:91]
    v_fma_f32 v22, -v49, v49, v30
    s_waitcnt lgkmcnt(8)
    v_mfma_f32_16x16x32_bf16 v[92:95], v[184:187], v[248:251], v[92:95]
    ds_read_b128 v[144:147], v194 offset:2048
    v_add_f32 v23, v31, v31
    v_mul_f32 v30, v22, v22
    v_mfma_f32_16x16x32_bf16 v[92:95], v[188:191], v[252:255], v[92:95]
    ds_read_b128 v[148:151], v195 offset:2048
    v_mul_f32 v31, v22, v23
    v_mfma_f32_16x16x32_bf16 v[76:79], v[188:191], v[244:247], v[76:79]
    v_fma_f32 v22, -v23, v23, v30
    v_mfma_f32_16x16x32_bf16 v[76:79], v[184:187], v[240:243], v[76:79]
    v_add_f32 v23, v31, v31
    s_waitcnt lgkmcnt(6)
    v_mfma_f32_16x16x32_bf16 v[64:67], v[128:131], v[224:227], v[64:67]
    s_mov_b32 exec_lo, 0xffff
    s_mov_b32 exec_hi, 0x0
    ds_read_b128 v[40:43], v122 offset:0
    s_mov_b64 exec, -1
    v_mul_f32 v30, v22, v22
    v_mfma_f32_16x16x32_bf16 v[64:67], v[132:135], v[228:231], v[64:67]
    ds_read_b128 v[152:155], v195 offset:3072
    v_mul_f32 v31, v22, v23
    s_waitcnt lgkmcnt(6)
    v_mfma_f32_16x16x32_bf16 v[80:83], v[132:135], v[236:239], v[80:83]
    ds_read_b128 v[156:159], v194 offset:3072
    v_fma_f32 v22, -v23, v23, v30
    v_add_f32 v23, v31, v31
    v_mfma_f32_16x16x32_bf16 v[80:83], v[128:131], v[232:235], v[80:83]
    v_mul_f32 v30, v22, v22
    s_waitcnt lgkmcnt(5)
    v_mfma_f32_16x16x32_bf16 v[84:87], v[136:139], v[232:235], v[84:87]
    s_barrier
    ds_read_b128 v[240:243], v206 offset:40960
    ds_read_b128 v[160:163], v194 offset:24576
    v_mfma_f32_16x16x32_bf16 v[84:87], v[140:143], v[236:239], v[84:87]
    ds_read_b128 v[244:247], v207 offset:40960
    ds_read_b128 v[164:167], v195 offset:24576
    v_mfma_f32_16x16x32_bf16 v[68:71], v[140:143], v[228:231], v[68:71]
    ds_read_b128 v[252:255], v207 offset:45056
    v_mul_f32 v31, v22, v23
    v_fma_f32 v50, -v23, v23, v30
    v_add_f32 v51, v31, v31
    v_mfma_f32_16x16x32_bf16 v[68:71], v[136:139], v[224:227], v[68:71]
    ds_read_b128 v[248:251], v206 offset:45056
    v_mul_f32 v30, v50, v50
    s_waitcnt lgkmcnt(9)
    v_mfma_f32_16x16x32_bf16 v[72:75], v[144:147], v[224:227], v[72:75]
    ds_read_b128 v[168:171], v195 offset:25600
    v_mul_f32 v31, v50, v51
    v_mfma_f32_16x16x32_bf16 v[72:75], v[148:151], v[228:231], v[72:75]
    ds_read_b128 v[172:175], v194 offset:25600
    v_fma_f32 v22, -v51, v51, v30
    v_add_f32 v23, v31, v31
    v_mfma_f32_16x16x32_bf16 v[88:91], v[148:151], v[236:239], v[88:91]
    v_mul_f32 v30, v22, v22
    v_mfma_f32_16x16x32_bf16 v[88:91], v[144:147], v[232:235], v[88:91]
    v_mul_f32 v31, v22, v23
    s_waitcnt lgkmcnt(8)
    v_mfma_f32_16x16x32_bf16 v[92:95], v[152:155], v[232:235], v[92:95]
    ds_read_b128 v[176:179], v194 offset:26624
    v_fma_f32 v24, -v23, v23, v30
    v_mfma_f32_16x16x32_bf16 v[92:95], v[156:159], v[236:239], v[92:95]
    ds_read_b128 v[180:183], v195 offset:26624
    v_add_f32 v25, v31, v31
    v_mfma_f32_16x16x32_bf16 v[76:79], v[156:159], v[228:231], v[76:79]
    v_mul_f32 v30, v24, v24
    v_mfma_f32_16x16x32_bf16 v[76:79], v[152:155], v[224:227], v[76:79]
    v_mul_f32 v31, v24, v25
    v_fma_f32 v52, -v25, v25, v30
    s_waitcnt lgkmcnt(6)
    v_mfma_f32_16x16x32_bf16 v[64:67], v[160:163], v[240:243], v[64:67]
    s_mov_b32 exec_lo, 0xffff0000
    s_mov_b32 exec_hi, 0x0
    ds_read_b128 v[40:43], v122 offset:24576
    s_mov_b64 exec, -1
    v_add_f32 v53, v31, v31
    v_mfma_f32_16x16x32_bf16 v[64:67], v[164:167], v[244:247], v[64:67]
    ds_read_b128 v[184:187], v195 offset:27648
    v_mul_f32 v30, v52, v52
    s_waitcnt lgkmcnt(6)
    v_mfma_f32_16x16x32_bf16 v[80:83], v[164:167], v[252:255], v[80:83]
    ds_read_b128 v[188:191], v194 offset:27648
    v_mul_f32 v31, v52, v53
    v_mfma_f32_16x16x32_bf16 v[80:83], v[160:163], v[248:251], v[80:83]
    v_fma_f32 v54, -v53, v53, v30
    s_waitcnt lgkmcnt(5)
    v_mfma_f32_16x16x32_bf16 v[84:87], v[168:171], v[248:251], v[84:87]
    s_barrier
    ds_read_b128 v[224:227], v208 offset:16384
    ds_read_b128 v[128:131], v196 offset:0
    v_mfma_f32_16x16x32_bf16 v[84:87], v[172:175], v[252:255], v[84:87]
    ds_read_b128 v[228:231], v209 offset:16384
    ds_read_b128 v[132:135], v197 offset:0
    v_mfma_f32_16x16x32_bf16 v[68:71], v[172:175], v[244:247], v[68:71]
    ds_read_b128 v[236:239], v209 offset:20480
    v_add_f32 v55, v31, v31
    v_mul_f32 v30, v54, v54
    v_mul_f32 v31, v54, v55
    v_fma_f32 v34, -v55, v55, v30
    v_mfma_f32_16x16x32_bf16 v[68:71], v[168:171], v[240:243], v[68:71]
    ds_read_b128 v[232:235], v208 offset:20480
    v_add_f32 v35, v31, v31
    s_waitcnt lgkmcnt(9)
    v_mfma_f32_16x16x32_bf16 v[72:75], v[176:179], v[240:243], v[72:75]
    ds_read_b128 v[136:139], v197 offset:1024
    v_mul_f32 v30, v34, v34
    v_mfma_f32_16x16x32_bf16 v[72:75], v[180:183], v[244:247], v[72:75]
    ds_read_b128 v[140:143], v196 offset:1024
    v_mul_f32 v31, v34, v35
    v_mfma_f32_16x16x32_bf16 v[88:91], v[180:183], v[252:255], v[88:91]
    v_fma_f32 v54, -v35, v35, v30
    v_mfma_f32_16x16x32_bf16 v[88:91], v[176:179], v[248:251], v[88:91]
    v_add_f32 v55, v31, v31
    s_waitcnt lgkmcnt(8)
    v_mfma_f32_16x16x32_bf16 v[92:95], v[184:187], v[248:251], v[92:95]
    ds_read_b128 v[144:147], v196 offset:2048
    v_and_b32 v26, 1, v3
    v_cmp_ne_u32 vcc, 0, v26
    v_mfma_f32_16x16x32_bf16 v[92:95], v[188:191], v[252:255], v[92:95]
    ds_read_b128 v[148:151], v197 offset:2048
    v_cndmask_b32 v56, 1.0, v50, vcc
    v_mfma_f32_16x16x32_bf16 v[76:79], v[188:191], v[244:247], v[76:79]
    v_cndmask_b32 v57, 0, v51, vcc
    v_mfma_f32_16x16x32_bf16 v[76:79], v[184:187], v[240:243], v[76:79]
    v_and_b32 v26, 2, v3
    s_waitcnt lgkmcnt(6)
    v_mfma_f32_16x16x32_bf16 v[64:67], v[128:131], v[224:227], v[64:67]
    s_mov_b32 exec_lo, 0x0
    s_mov_b32 exec_hi, 0xffff
    ds_read_b128 v[40:43], v123 offset:0
    s_mov_b64 exec, -1
    v_cmp_ne_u32 vcc, 0, v26
    v_mfma_f32_16x16x32_bf16 v[64:67], v[132:135], v[228:231], v[64:67]
    ds_read_b128 v[152:155], v197 offset:3072
    v_cndmask_b32 v22, 1.0, v22, vcc
    s_waitcnt lgkmcnt(6)
    v_mfma_f32_16x16x32_bf16 v[80:83], v[132:135], v[236:239], v[80:83]
    ds_read_b128 v[156:159], v196 offset:3072
    v_cndmask_b32 v23, 0, v23, vcc
    v_mfma_f32_16x16x32_bf16 v[80:83], v[128:131], v[232:235], v[80:83]
    v_and_b32 v26, 4, v3
    v_cmp_ne_u32 vcc, 0, v26
    s_waitcnt lgkmcnt(5)
    v_mfma_f32_16x16x32_bf16 v[84:87], v[136:139], v[232:235], v[84:87]
    s_barrier
    ds_read_b128 v[240:243], v208 offset:40960
    ds_read_b128 v[160:163], v196 offset:24576
    v_mfma_f32_16x16x32_bf16 v[84:87], v[140:143], v[236:239], v[84:87]
    ds_read_b128 v[244:247], v209 offset:40960
    ds_read_b128 v[164:167], v197 offset:24576
    v_mfma_f32_16x16x32_bf16 v[68:71], v[140:143], v[228:231], v[68:71]
    ds_read_b128 v[252:255], v209 offset:45056
    v_cndmask_b32 v24, 1.0, v24, vcc
    v_cndmask_b32 v25, 0, v25, vcc
    v_mul_f32 v30, v56, v22
    v_mfma_f32_16x16x32_bf16 v[68:71], v[136:139], v[224:227], v[68:71]
    ds_read_b128 v[248:251], v208 offset:45056
    v_mul_f32 v31, v56, v23
    s_waitcnt lgkmcnt(9)
    v_mfma_f32_16x16x32_bf16 v[72:75], v[144:147], v[224:227], v[72:75]
    ds_read_b128 v[168:171], v197 offset:25600
    v_fma_f32 v30, -v57, v23, v30
    v_mfma_f32_16x16x32_bf16 v[72:75], v[148:151], v[228:231], v[72:75]
    ds_read_b128 v[172:175], v196 offset:25600
    v_fma_f32 v57, v57, v22, v31
    v_mov_b32 v56, v30
    v_mfma_f32_16x16x32_bf16 v[88:91], v[148:151], v[236:239], v[88:91]
    v_mul_f32 v30, v56, v24
    v_mfma_f32_16x16x32_bf16 v[88:91], v[144:147], v[232:235], v[88:91]
    v_mul_f32 v31, v56, v25
    s_waitcnt lgkmcnt(8)
    v_mfma_f32_16x16x32_bf16 v[92:95], v[152:155], v[232:235], v[92:95]
    ds_read_b128 v[176:179], v196 offset:26624
    v_fma_f32 v30, -v57, v25, v30
    v_mfma_f32_16x16x32_bf16 v[92:95], v[156:159], v[236:239], v[92:95]
    ds_read_b128 v[180:183], v197 offset:26624
    v_fma_f32 v57, v57, v24, v31
    v_mfma_f32_16x16x32_bf16 v[76:79], v[156:159], v[228:231], v[76:79]
    v_mov_b32 v56, v30
    v_mfma_f32_16x16x32_bf16 v[76:79], v[152:155], v[224:227], v[76:79]
    v_mul_lo_u32 v115, v115, s71
    v_mov_b32 v2, s71
    s_waitcnt lgkmcnt(8)
    v_mfma_f32_16x16x32_bf16 v[64:67], v[160:163], v[240:243], v[64:67]
    s_mov_b32 exec_lo, 0x0
    s_mov_b32 exec_hi, 0xffff0000
    ds_read_b128 v[40:43], v123 offset:24576
    s_mov_b64 exec, -1
    s_waitcnt lgkmcnt(7)
    v_mfma_f32_16x16x32_bf16 v[64:67], v[164:167], v[244:247], v[64:67]
    ds_read_b128 v[184:187], v197 offset:27648
    s_waitcnt lgkmcnt(7)
    v_mfma_f32_16x16x32_bf16 v[80:83], v[164:167], v[252:255], v[80:83]
    ds_read_b128 v[188:191], v196 offset:27648
    s_waitcnt lgkmcnt(7)
    v_mfma_f32_16x16x32_bf16 v[80:83], v[160:163], v[248:251], v[80:83]
    s_waitcnt lgkmcnt(5)
    v_mfma_f32_16x16x32_bf16 v[84:87], v[168:171], v[248:251], v[84:87]
    v_mfma_f32_16x16x32_bf16 v[84:87], v[172:175], v[252:255], v[84:87]
    v_mfma_f32_16x16x32_bf16 v[68:71], v[172:175], v[244:247], v[68:71]
    v_mfma_f32_16x16x32_bf16 v[68:71], v[168:171], v[240:243], v[68:71]
    s_waitcnt lgkmcnt(3)
    v_mfma_f32_16x16x32_bf16 v[72:75], v[176:179], v[240:243], v[72:75]
    v_mfma_f32_16x16x32_bf16 v[72:75], v[180:183], v[244:247], v[72:75]
    v_fma_f32 v22, v48, v64, v65
    v_fma_f32 v23, v48, v80, v81
    v_mfma_f32_16x16x32_bf16 v[88:91], v[180:183], v[252:255], v[88:91]
    v_fma_f32 v22, -v49, v80, v22
    v_fmac_f32 v23, v49, v64
    v_mfma_f32_16x16x32_bf16 v[88:91], v[176:179], v[248:251], v[88:91]
    v_fma_f32 v20, v48, v22, v66
    v_fma_f32 v21, v48, v23, v82
    s_waitcnt lgkmcnt(0)
    v_mfma_f32_16x16x32_bf16 v[92:95], v[184:187], v[248:251], v[92:95]
    v_fma_f32 v20, -v49, v23, v20
    v_fmac_f32 v21, v49, v22
    v_mfma_f32_16x16x32_bf16 v[92:95], v[188:191], v[252:255], v[92:95]
    v_fma_f32 v22, v48, v20, v67
    v_fma_f32 v23, v48, v21, v83
    v_mfma_f32_16x16x32_bf16 v[76:79], v[188:191], v[244:247], v[76:79]
    v_fma_f32 v22, -v49, v21, v22
    v_fmac_f32 v23, v49, v20
    v_mfma_f32_16x16x32_bf16 v[76:79], v[184:187], v[240:243], v[76:79]
    v_fma_f32 v20, v48, v22, v68
    v_fma_f32 v21, v48, v23, v84
    v_fma_f32 v20, -v49, v23, v20
    v_fmac_f32 v21, v49, v22
    v_fma_f32 v22, v48, v20, v69
    v_fma_f32 v23, v48, v21, v85
    v_fma_f32 v22, -v49, v21, v22
    v_fmac_f32 v23, v49, v20
    v_fma_f32 v20, v48, v22, v70
    v_fma_f32 v21, v48, v23, v86
    v_fma_f32 v20, -v49, v23, v20
    v_fmac_f32 v21, v49, v22
    v_fma_f32 v22, v48, v20, v71
    v_fma_f32 v23, v48, v21, v87
    v_fma_f32 v22, -v49, v21, v22
    v_fmac_f32 v23, v49, v20
    v_fma_f32 v20, v48, v22, v72
    v_fma_f32 v21, v48, v23, v88
    v_fma_f32 v20, -v49, v23, v20
    v_fmac_f32 v21, v49, v22
    v_fma_f32 v22, v48, v20, v73
    v_fma_f32 v23, v48, v21, v89
    v_fma_f32 v22, -v49, v21, v22
    v_fmac_f32 v23, v49, v20
    v_fma_f32 v20, v48, v22, v74
    v_fma_f32 v21, v48, v23, v90
    v_fma_f32 v20, -v49, v23, v20
    v_fmac_f32 v21, v49, v22
    v_fma_f32 v22, v48, v20, v75
    v_fma_f32 v23, v48, v21, v91
    v_fma_f32 v22, -v49, v21, v22
    v_fmac_f32 v23, v49, v20
    v_fma_f32 v20, v48, v22, v76
    v_fma_f32 v21, v48, v23, v92
    v_fma_f32 v20, -v49, v23, v20
    v_fmac_f32 v21, v49, v22
    v_fma_f32 v22, v48, v20, v77
    v_fma_f32 v23, v48, v21, v93
    v_fma_f32 v22, -v49, v21, v22
    v_fmac_f32 v23, v49, v20
    v_fma_f32 v20, v48, v22, v78
    v_fma_f32 v21, v48, v23, v94
    v_fma_f32 v20, -v49, v23, v20
    v_fmac_f32 v21, v49, v22
    v_fma_f32 v22, v48, v20, v79
    v_fma_f32 v23, v48, v21, v95
    v_fma_f32 v22, -v49, v21, v22
    v_fmac_f32 v23, v49, v20
    ds_write_b64 v118, v[22:23]
    v_pk_mul_f32 v[4:5], v[58:59], v[80:81] op_sel:[1,0] op_sel_hi:[1,1]
    v_pk_mul_f32 v[6:7], v[58:59], v[64:65] op_sel:[1,0] op_sel_hi:[1,1]
    v_pk_mul_f32 v[8:9], v[58:59], v[82:83] op_sel:[1,0] op_sel_hi:[1,1]
    v_pk_mul_f32 v[10:11], v[58:59], v[66:67] op_sel:[1,0] op_sel_hi:[1,1]
    v_pk_fma_f32 v[64:65], v[58:59], v[64:65], v[4:5] op_sel_hi:[0,1,1] neg_lo:[0,0,1] neg_hi:[0,0,1]
    v_pk_fma_f32 v[80:81], v[58:59], v[80:81], v[6:7] op_sel_hi:[0,1,1]
    v_pk_fma_f32 v[66:67], v[58:59], v[66:67], v[8:9] op_sel_hi:[0,1,1] neg_lo:[0,0,1] neg_hi:[0,0,1]
    v_pk_fma_f32 v[82:83], v[58:59], v[82:83], v[10:11] op_sel_hi:[0,1,1]
    v_pk_mul_f32 v[4:5], v[58:59], v[84:85] op_sel:[1,0] op_sel_hi:[1,1]
    v_pk_mul_f32 v[6:7], v[58:59], v[68:69] op_sel:[1,0] op_sel_hi:[1,1]
    v_pk_mul_f32 v[8:9], v[58:59], v[86:87] op_sel:[1,0] op_sel_hi:[1,1]
    v_pk_mul_f32 v[10:11], v[58:59], v[70:71] op_sel:[1,0] op_sel_hi:[1,1]
    v_pk_fma_f32 v[68:69], v[58:59], v[68:69], v[4:5] op_sel_hi:[0,1,1] neg_lo:[0,0,1] neg_hi:[0,0,1]
    v_pk_fma_f32 v[84:85], v[58:59], v[84:85], v[6:7] op_sel_hi:[0,1,1]
    v_pk_fma_f32 v[70:71], v[58:59], v[70:71], v[8:9] op_sel_hi:[0,1,1] neg_lo:[0,0,1] neg_hi:[0,0,1]
    v_pk_fma_f32 v[86:87], v[58:59], v[86:87], v[10:11] op_sel_hi:[0,1,1]
    v_pk_mul_f32 v[4:5], v[58:59], v[88:89] op_sel:[1,0] op_sel_hi:[1,1]
    v_pk_mul_f32 v[6:7], v[58:59], v[72:73] op_sel:[1,0] op_sel_hi:[1,1]
    v_pk_mul_f32 v[8:9], v[58:59], v[90:91] op_sel:[1,0] op_sel_hi:[1,1]
    v_pk_mul_f32 v[10:11], v[58:59], v[74:75] op_sel:[1,0] op_sel_hi:[1,1]
    v_pk_fma_f32 v[72:73], v[58:59], v[72:73], v[4:5] op_sel_hi:[0,1,1] neg_lo:[0,0,1] neg_hi:[0,0,1]
    v_pk_fma_f32 v[88:89], v[58:59], v[88:89], v[6:7] op_sel_hi:[0,1,1]
    v_pk_fma_f32 v[74:75], v[58:59], v[74:75], v[8:9] op_sel_hi:[0,1,1] neg_lo:[0,0,1] neg_hi:[0,0,1]
    v_pk_fma_f32 v[90:91], v[58:59], v[90:91], v[10:11] op_sel_hi:[0,1,1]
    v_pk_mul_f32 v[4:5], v[58:59], v[92:93] op_sel:[1,0] op_sel_hi:[1,1]
    v_pk_mul_f32 v[6:7], v[58:59], v[76:77] op_sel:[1,0] op_sel_hi:[1,1]
    v_pk_mul_f32 v[8:9], v[58:59], v[94:95] op_sel:[1,0] op_sel_hi:[1,1]
    v_pk_mul_f32 v[10:11], v[58:59], v[78:79] op_sel:[1,0] op_sel_hi:[1,1]
    v_pk_fma_f32 v[76:77], v[58:59], v[76:77], v[4:5] op_sel_hi:[0,1,1] neg_lo:[0,0,1] neg_hi:[0,0,1]
    v_pk_fma_f32 v[92:93], v[58:59], v[92:93], v[6:7] op_sel_hi:[0,1,1]
    v_pk_fma_f32 v[78:79], v[58:59], v[78:79], v[8:9] op_sel_hi:[0,1,1] neg_lo:[0,0,1] neg_hi:[0,0,1]
    v_pk_fma_f32 v[94:95], v[58:59], v[94:95], v[10:11] op_sel_hi:[0,1,1]
    s_waitcnt lgkmcnt(0)
    s_barrier
    ds_read_b64 v[4:5], v119 offset:0
    ds_read_b64 v[6:7], v119 offset:256
    ds_read_b64 v[8:9], v119 offset:512
    ds_read_b64 v[10:11], v119 offset:768
    ds_read_b64 v[12:13], v119 offset:1024
    ds_read_b64 v[14:15], v119 offset:1280
    ds_read_b64 v[16:17], v119 offset:1536
    ds_read_b64 v[18:19], v119 offset:1792
    s_add_u32 m0, s101, 49152
    s_add_u32 s99, s68, 2
    s_and_b32 s99, s99, 7
    s_mul_i32 s99, s99, 176128
    buffer_load_dwordx4 v60, s[60:63], s99 offen offset:0 lds
    s_waitcnt lgkmcnt(6)
    v_fma_f32 v6, v50, v4, v6
    v_fma_f32 v7, v50, v5, v7
    v_fma_f32 v6, -v51, v5, v6
    v_fmac_f32 v7, v51, v4
    s_waitcnt lgkmcnt(5)
    v_fma_f32 v8, v50, v6, v8
    v_fma_f32 v9, v50, v7, v9
    v_fma_f32 v8, -v51, v7, v8
    buffer_load_dwordx4 v61, s[60:63], s99 offen offset:1024 lds
    v_fmac_f32 v9, v51, v6
    s_waitcnt lgkmcnt(4)
    v_fma_f32 v10, v50, v8, v10
    v_fma_f32 v11, v50, v9, v11
    v_fma_f32 v10, -v51, v9, v10
    v_fmac_f32 v11, v51, v8
    s_waitcnt lgkmcnt(3)
    v_fma_f32 v12, v50, v10, v12
    v_fma_f32 v13, v50, v11, v13
    buffer_load_dwordx4 v62, s[60:63], s99 offen offset:2048 lds
    v_fma_f32 v12, -v51, v11, v12
    v_fmac_f32 v13, v51, v10
    s_waitcnt lgkmcnt(2)
    v_fma_f32 v14, v50, v12, v14
    v_fma_f32 v15, v50, v13, v15
    v_fma_f32 v14, -v51, v13, v14
    v_fmac_f32 v15, v51, v12
    s_waitcnt lgkmcnt(1)
    v_fma_f32 v16, v50, v14, v16
    s_add_u32 m0, s101, 52224
    s_add_u32 s99, s99, 44032
    buffer_load_dwordx4 v60, s[60:63], s99 offen offset:0 lds
    v_fma_f32 v17, v50, v15, v17
    v_fma_f32 v16, -v51, v15, v16
    v_fmac_f32 v17, v51, v14
    s_waitcnt lgkmcnt(0)
    v_fma_f32 v18, v50, v16, v18
    v_fma_f32 v19, v50, v17, v19
    v_fma_f32 v18, -v51, v17, v18
    v_fmac_f32 v19, v51, v16
    v_mov_b32 v20, s71
    v_mov_b32 v21, s71
    s_mov_b64 exec, 0xffff
    buffer_store_dwordx4 v[18:21], v120, s[44:47], s90 offen sc1
    s_mov_b64 exec, -1
    buffer_load_dwordx4 v61, s[60:63], s99 offen offset:1024 lds
    buffer_load_dwordx4 v62, s[60:63], s99 offen offset:2048 lds
    global_load_dwordx4 v[44:47], v124, s[30:31]
    global_load_dwordx4 v[192:195], v125, s[30:31]
    s_barrier
    s_add_u32 m0, s101, 73728
    s_add_u32 s99, s68, 3
    s_and_b32 s99, s99, 7
    s_mul_i32 s99, s99, 176128
    buffer_load_dwordx4 v60, s[60:63], s99 offen offset:0 lds
    v_mov_b32 v32, 0
    buffer_load_dwordx4 v61, s[60:63], s99 offen offset:1024 lds
    v_mov_b32 v33, 0
    buffer_load_dwordx4 v62, s[60:63], s99 offen offset:2048 lds
    v_cmp_eq_u32 vcc, 1, v3
    s_nop 1
    v_cndmask_b32 v32, v32, v4, vcc
    v_cndmask_b32 v33, v33, v5, vcc
    s_add_u32 m0, s101, 76800
    s_add_u32 s99, s99, 44032
    buffer_load_dwordx4 v60, s[60:63], s99 offen offset:0 lds
    v_cmp_eq_u32 vcc, 2, v3
    s_nop 1
    v_cndmask_b32 v32, v32, v6, vcc
    v_cndmask_b32 v33, v33, v7, vcc
    buffer_load_dwordx4 v61, s[60:63], s99 offen offset:1024 lds
    v_cmp_eq_u32 vcc, 3, v3
    s_nop 1
    v_cndmask_b32 v32, v32, v8, vcc
    v_cndmask_b32 v33, v33, v9, vcc
    buffer_load_dwordx4 v62, s[60:63], s99 offen offset:2048 lds
    v_cmp_eq_u32 vcc, 4, v3
    s_nop 1
    v_cndmask_b32 v32, v32, v10, vcc
    v_cndmask_b32 v33, v33, v11, vcc
    s_xor_b32 s100, s88, 0
    s_add_u32 m0, s101, 98304
    s_nop 0
    buffer_load_dwordx4 v96, s[48:51], s100 offen offset:0 lds
    v_cmp_eq_u32 vcc, 5, v3
    s_nop 1
    v_cndmask_b32 v32, v32, v12, vcc
    v_cndmask_b32 v33, v33, v13, vcc
    buffer_load_dwordx4 v97, s[48:51], s100 offen offset:1024 lds
    v_cmp_eq_u32 vcc, 6, v3
    s_nop 1
    v_cndmask_b32 v32, v32, v14, vcc
    v_cndmask_b32 v33, v33, v15, vcc
    buffer_load_dwordx4 v98, s[48:51], s100 offen offset:2048 lds
    v_cmp_eq_u32 vcc, 7, v3
    s_nop 1
    v_cndmask_b32 v32, v32, v16, vcc
    v_cndmask_b32 v33, v33, v17, vcc
    buffer_load_dwordx4 v99, s[48:51], s100 offen offset:3072 lds
    s_waitcnt vmcnt(12)
    s_barrier
    s_add_u32 m0, s101, 0
    s_add_u32 s99, s68, 4
    s_and_b32 s99, s99, 7
    s_mul_i32 s99, s99, 176128
    buffer_load_dwordx4 v60, s[60:63], s99 offen offset:0 lds
    s_waitcnt vmcnt(11)
    v_lshlrev_b32 v24, 16, v44
    v_and_b32 v25, 0xffff0000, v44
    v_lshlrev_b32 v26, 16, v36
    v_and_b32 v27, 0xffff0000, v36
    v_mul_f32 v26, v26, v24
    v_mul_f32 v27, v27, v25
    v_cvt_pk_bf16_f32 v26, v26, v27
    v_lshlrev_b32 v28, 16, v26
    buffer_load_dwordx4 v61, s[60:63], s99 offen offset:1024 lds
    v_and_b32 v29, 0xffff0000, v26
    v_lshlrev_b32 v24, 16, v45
    v_and_b32 v25, 0xffff0000, v45
    v_lshlrev_b32 v26, 16, v37
    v_and_b32 v27, 0xffff0000, v37
    v_mul_f32 v26, v26, v24
    v_mul_f32 v27, v27, v25
    v_cvt_pk_bf16_f32 v26, v26, v27
    v_lshlrev_b32 v27, 16, v26
    buffer_load_dwordx4 v62, s[60:63], s99 offen offset:2048 lds
    v_and_b32 v26, 0xffff0000, v26
    v_add_f32 v28, v28, v27
    v_add_f32 v29, v29, v26
    v_lshlrev_b32 v24, 16, v46
    v_and_b32 v25, 0xffff0000, v46
    v_lshlrev_b32 v26, 16, v38
    v_and_b32 v27, 0xffff0000, v38
    v_mul_f32 v26, v26, v24
    v_mul_f32 v27, v27, v25
    s_add_u32 m0, s101, 3072
    s_add_u32 s99, s99, 44032
    buffer_load_dwordx4 v60, s[60:63], s99 offen offset:0 lds
    v_cvt_pk_bf16_f32 v26, v26, v27
    v_lshlrev_b32 v27, 16, v26
    v_and_b32 v26, 0xffff0000, v26
    v_add_f32 v28, v28, v27
    v_add_f32 v29, v29, v26
    v_lshlrev_b32 v24, 16, v47
    v_and_b32 v25, 0xffff0000, v47
    v_lshlrev_b32 v26, 16, v39
    v_and_b32 v27, 0xffff0000, v39
    buffer_load_dwordx4 v61, s[60:63], s99 offen offset:1024 lds
    v_mul_f32 v26, v26, v24
    v_mul_f32 v27, v27, v25
    v_cvt_pk_bf16_f32 v26, v26, v27
    v_lshlrev_b32 v27, 16, v26
    v_and_b32 v26, 0xffff0000, v26
    v_add_f32 v28, v28, v27
    v_add_f32 v29, v29, v26
    v_lshlrev_b32 v24, 16, v192
    v_and_b32 v25, 0xffff0000, v192
    buffer_load_dwordx4 v62, s[60:63], s99 offen offset:2048 lds
    v_lshlrev_b32 v26, 16, v40
    v_and_b32 v27, 0xffff0000, v40
    v_mul_f32 v26, v26, v24
    v_mul_f32 v27, v27, v25
    v_cvt_pk_bf16_f32 v26, v26, v27
    v_lshlrev_b32 v27, 16, v26
    v_and_b32 v26, 0xffff0000, v26
    v_add_f32 v28, v28, v27
    s_waitcnt vmcnt(10)
    s_barrier
    s_add_u32 m0, s78, 155648
    s_nop 0
    buffer_load_dwordx4 v110, s[44:47], s91 offen offset:0 sc1 lds
    v_add_f32 v29, v29, v26
    v_lshlrev_b32 v24, 16, v193
    v_and_b32 v25, 0xffff0000, v193
    v_lshlrev_b32 v26, 16, v41
    buffer_load_dwordx4 v111, s[44:47], s91 offen offset:1024 sc1 lds
    v_and_b32 v27, 0xffff0000, v41
    v_mul_f32 v26, v26, v24
    v_mul_f32 v27, v27, v25
    s_add_u32 m0, s101, 24576
    s_add_u32 s99, s68, 5
    s_and_b32 s99, s99, 7
    s_mul_i32 s99, s99, 176128
    buffer_load_dwordx4 v60, s[60:63], s99 offen offset:0 lds
    v_cvt_pk_bf16_f32 v26, v26, v27
    v_lshlrev_b32 v27, 16, v26
    v_and_b32 v26, 0xffff0000, v26
    buffer_load_dwordx4 v61, s[60:63], s99 offen offset:1024 lds
    v_add_f32 v28, v28, v27
    v_add_f32 v29, v29, v26
    v_lshlrev_b32 v24, 16, v194
    buffer_load_dwordx4 v62, s[60:63], s99 offen offset:2048 lds
    v_and_b32 v25, 0xffff0000, v194
    v_lshlrev_b32 v26, 16, v42
    v_and_b32 v27, 0xffff0000, v42
    v_mul_f32 v26, v26, v24
    s_add_u32 m0, s101, 27648
    s_add_u32 s99, s99, 44032
    buffer_load_dwordx4 v60, s[60:63], s99 offen offset:0 lds
    v_mul_f32 v27, v27, v25
    v_cvt_pk_bf16_f32 v26, v26, v27
    v_lshlrev_b32 v27, 16, v26
    buffer_load_dwordx4 v61, s[60:63], s99 offen offset:1024 lds
    v_and_b32 v26, 0xffff0000, v26
    v_add_f32 v28, v28, v27
    v_add_f32 v29, v29, v26
    buffer_load_dwordx4 v62, s[60:63], s99 offen offset:2048 lds
    v_lshlrev_b32 v24, 16, v195
    v_and_b32 v25, 0xffff0000, v195
    v_lshlrev_b32 v26, 16, v43
    s_add_u32 m0, s101, 122880
    s_nop 0
    buffer_load_dwordx4 v108, s[56:59], s93 offen offset:0 lds
    v_and_b32 v27, 0xffff0000, v43
    v_mul_f32 v26, v26, v24
    v_mul_f32 v27, v27, v25
    v_cvt_pk_bf16_f32 v26, v26, v27
    buffer_load_dwordx4 v109, s[56:59], s93 offen offset:1024 lds
    v_lshlrev_b32 v27, 16, v26
    v_and_b32 v26, 0xffff0000, v26
    v_add_f32 v28, v28, v27
    s_add_u32 m0, s101, 124928
    s_add_u32 s93, s93, 16384
    buffer_load_dwordx4 v108, s[56:59], s93 offen offset:0 lds
    v_add_f32 v29, v29, v26
    v_add_f32 v28, v28, v29
    s_nop 1
    v_add_f32_dpp v28, v28, v28 row_shr:1 row_mask:0xf bank_mask:0xf
    buffer_load_dwordx4 v109, s[56:59], s93 offen offset:1024 lds
    s_nop 0
    v_add_f32_dpp v28, v28, v28 row_shr:2 row_mask:0xf bank_mask:0xf
    s_nop 1
    v_add_f32_dpp v28, v28, v28 row_shr:4 row_mask:0xf bank_mask:0xf
    v_mov_b32 v29, v28
    s_add_u32 m0, s101, 126976
    s_add_u32 s93, s93, 16384
    s_cmp_eq_u32 s93, s95
    s_cselect_b32 s93, s94, s93
    buffer_load_dwordx4 v108, s[56:59], s93 offen offset:0 lds
    v_permlane32_swap_b32 v28, v29
    v_add_f32 v28, v28, v29
    v_mov_b32 v29, v28
    s_nop 1
    v_permlane16_swap_b32 v28, v29
    buffer_load_dwordx4 v109, s[56:59], s93 offen offset:1024 lds
    v_add_f32 v28, v28, v29
    v_cvt_pk_bf16_f32 v28, v28, v28
    v_lshlrev_b32 v28, 16, v28
    s_add_u32 m0, s101, 102400
    s_add_u32 s93, s93, 16384
    buffer_load_dwordx4 v108, s[56:59], s93 offen offset:0 lds
    v_mul_f32 v28, 0xbfb8aa3b, v28
    v_exp_f32 v28, v28
    s_nop 0
    v_add_f32 v28, 1.0, v28
    buffer_load_dwordx4 v109, s[56:59], s93 offen offset:1024 lds
    v_rcp_f32 v28, v28
    s_nop 0
    v_cvt_pk_bf16_f32 v28, v28, v28
    v_lshlrev_b32 v28, 16, v28
    s_waitcnt vmcnt(14)
    s_barrier
    ds_read_b128 v[224:227], v113 offset:0
    ds_read_b128 v[228:231], v113 offset:512
    ds_read_b128 v[232:235], v113 offset:1024
    ds_read_b128 v[236:239], v113 offset:1536
    s_add_u32 m0, s101, 49152
    s_add_u32 s99, s68, 6
    s_and_b32 s99, s99, 7
    s_mul_i32 s99, s99, 176128
    buffer_load_dwordx4 v60, s[60:63], s99 offen offset:0 lds
    s_waitcnt lgkmcnt(0)
    v_add3_u32 v4, v226, v230, v234
    v_add_u32 v4, v4, v238
    v_cmp_ne_u32 vcc, v4, v115
    s_nop 1
    s_cbranch_vccnz L_pollE
L_pollE_out:
    v_fma_f32 v232, v52, v236, v232
    v_fma_f32 v233, v52, v237, v233
    v_fma_f32 v232, -v53, v237, v232
    v_fmac_f32 v233, v53, v236
    v_fma_f32 v228, v52, v232, v228
    v_fma_f32 v229, v52, v233, v229
    v_fma_f32 v228, -v53, v233, v228
    v_fmac_f32 v229, v53, v232
    v_fma_f32 v224, v52, v228, v224
    v_fma_f32 v225, v52, v229, v225
    v_fma_f32 v224, -v53, v229, v224
    buffer_load_dwordx4 v61, s[60:63], s99 offen offset:1024 lds
    v_fmac_f32 v225, v53, v228
    v_mov_b32 v6, v224
    v_mov_b32 v7, v225
    s_nop 0
    v_permlane16_swap_b32 v6, v224
    v_permlane16_swap_b32 v7, v225
    v_fma_f32 v6, v34, v224, v6
    v_fma_f32 v7, v34, v225, v7
    v_fma_f32 v6, -v35, v225, v6
    v_fmac_f32 v7, v35, v224
    v_mov_b32 v4, v6
    v_mov_b32 v5, v7
    s_nop 0
    v_permlane32_swap_b32 v4, v6
    buffer_load_dwordx4 v62, s[60:63], s99 offen offset:2048 lds
    v_permlane32_swap_b32 v5, v7
    v_fma_f32 v4, v54, v6, v4
    v_fma_f32 v5, v54, v7, v5
    v_fma_f32 v4, -v55, v7, v4
    v_fmac_f32 v5, v55, v6
    v_fma_f32 v32, v56, v4, v32
    v_fma_f32 v33, v56, v5, v33
    v_fma_f32 v32, -v57, v5, v32
    v_fmac_f32 v33, v57, v4
    v_mul_f32 v6, v58, v32
    v_mul_f32 v7, v58, v33
    v_fma_f32 v6, -v59, v33, v6
    s_add_u32 m0, s101, 52224
    s_add_u32 s99, s99, 44032
    buffer_load_dwordx4 v60, s[60:63], s99 offen offset:0 lds
    v_fmac_f32 v7, v59, v32
    v_fmac_f32 v64, v48, v6
    v_fmac_f32 v80, v48, v7
    v_fma_f32 v64, -v49, v7, v64
    v_fmac_f32 v80, v49, v6
    v_fmac_f32 v65, v48, v64
    v_fmac_f32 v81, v48, v80
    v_fma_f32 v65, -v49, v80, v65
    v_fmac_f32 v81, v49, v64
    v_fmac_f32 v66, v48, v65
    v_fmac_f32 v82, v48, v81
    v_fma_f32 v66, -v49, v81, v66
    buffer_load_dwordx4 v61, s[60:63], s99 offen offset:1024 lds
    v_fmac_f32 v82, v49, v65
    v_fmac_f32 v67, v48, v66
    v_fmac_f32 v83, v48, v82
    v_fma_f32 v67, -v49, v82, v67
    v_fmac_f32 v83, v49, v66
    v_fmac_f32 v68, v48, v67
    v_fmac_f32 v84, v48, v83
    v_fma_f32 v68, -v49, v83, v68
    v_fmac_f32 v84, v49, v67
    v_fmac_f32 v69, v48, v68
    v_fmac_f32 v85, v48, v84
    v_fma_f32 v69, -v49, v84, v69
    buffer_load_dwordx4 v62, s[60:63], s99 offen offset:2048 lds
    v_fmac_f32 v85, v49, v68
    v_fmac_f32 v70, v48, v69
    v_fmac_f32 v86, v48, v85
    v_fma_f32 v70, -v49, v85, v70
    v_fmac_f32 v86, v49, v69
    v_fmac_f32 v71, v48, v70
    v_fmac_f32 v87, v48, v86
    v_fma_f32 v71, -v49, v86, v71
    v_fmac_f32 v87, v49, v70
    v_fmac_f32 v72, v48, v71
    v_fmac_f32 v88, v48, v87
    s_waitcnt vmcnt(14)
    s_barrier
    v_fma_f32 v72, -v49, v87, v72
    s_add_u32 m0, s101, 73728
    s_add_u32 s99, s68, 7
    s_and_b32 s99, s99, 7
    s_mul_i32 s99, s99, 176128
    buffer_load_dwordx4 v60, s[60:63], s99 offen offset:0 lds
    v_fmac_f32 v88, v49, v71
    v_fmac_f32 v73, v48, v72
    v_fmac_f32 v89, v48, v88
    v_fma_f32 v73, -v49, v88, v73
    v_fmac_f32 v89, v49, v72
    buffer_load_dwordx4 v61, s[60:63], s99 offen offset:1024 lds
    v_fmac_f32 v74, v48, v73
    v_fmac_f32 v90, v48, v89
    v_fma_f32 v74, -v49, v89, v74
    v_fmac_f32 v90, v49, v73
    v_fmac_f32 v75, v48, v74
    buffer_load_dwordx4 v62, s[60:63], s99 offen offset:2048 lds
    v_fmac_f32 v91, v48, v90
    v_fma_f32 v75, -v49, v90, v75
    v_fmac_f32 v91, v49, v74
    v_fmac_f32 v76, v48, v75
    v_fmac_f32 v92, v48, v91
    s_add_u32 m0, s101, 76800
    s_add_u32 s99, s99, 44032
    buffer_load_dwordx4 v60, s[60:63], s99 offen offset:0 lds
    v_fma_f32 v76, -v49, v91, v76
    v_fmac_f32 v92, v49, v75
    v_fmac_f32 v77, v48, v76
    v_fmac_f32 v93, v48, v92
    v_fma_f32 v77, -v49, v92, v77
    buffer_load_dwordx4 v61, s[60:63], s99 offen offset:1024 lds
    v_fmac_f32 v93, v49, v76
    v_fmac_f32 v78, v48, v77
    v_fmac_f32 v94, v48, v93
    v_fma_f32 v78, -v49, v93, v78
    v_fmac_f32 v94, v49, v77
    buffer_load_dwordx4 v62, s[60:63], s99 offen offset:2048 lds
    v_fmac_f32 v79, v48, v78
    v_fmac_f32 v95, v48, v94
    v_fma_f32 v79, -v49, v94, v79
    v_fmac_f32 v95, v49, v78
    v_cvt_pk_bf16_f32 v8, v64, v65
    v_cvt_pk_bf16_f32 v16, -v80, -v81
    v_cvt_pk_bf16_f32 v9, v66, v67
    v_cvt_pk_bf16_f32 v17, -v82, -v83
    v_cvt_pk_bf16_f32 v10, v68, v69
    v_cvt_pk_bf16_f32 v18, -v84, -v85
    v_cvt_pk_bf16_f32 v11, v70, v71
    v_cvt_pk_bf16_f32 v19, -v86, -v87
    v_cvt_pk_bf16_f32 v12, v72, v73
    v_cvt_pk_bf16_f32 v20, -v88, -v89
    v_cvt_pk_bf16_f32 v13, v74, v75
    v_cvt_pk_bf16_f32 v21, -v90, -v91
    v_cvt_pk_bf16_f32 v14, v76, v77
    v_cvt_pk_bf16_f32 v22, -v92, -v93
    v_cvt_pk_bf16_f32 v15, v78, v79
    v_cvt_pk_bf16_f32 v23, -v94, -v95
    v_permlane16_swap_b32 v8, v16
    v_permlane16_swap_b32 v9, v17
    v_permlane16_swap_b32 v10, v18
    v_permlane16_swap_b32 v11, v19
    v_permlane16_swap_b32 v12, v20
    v_permlane16_swap_b32 v13, v21
    v_permlane16_swap_b32 v14, v22
    v_permlane16_swap_b32 v15, v23
    s_add_u32 s73, s86, 4096
    s_add_u32 s74, s86, 71424
    s_add_u32 s75, s86, 75520
    v_mfma_f32_32x32x16_bf16 v[64:79], v[8:11], v[216:219], 0
    v_mfma_f32_32x32x16_bf16 v[64:79], v[12:15], v[220:223], v[64:79]
    v_mfma_f32_32x32x16_bf16 v[80:95], v[16:19], v[216:219], 0
    v_mfma_f32_32x32x16_bf16 v[80:95], v[20:23], v[220:223], v[80:95]
    s_mov_b64 exec, 0x8080
    buffer_store_dword v28, v126, s[44:47], s79 offen sc1
    s_mov_b64 exec, -1
    s_nop 6
    v_cvt_pk_bf16_f32 v8, v64, v65
    v_cvt_pk_bf16_f32 v9, v66, v67
    v_cvt_pk_bf16_f32 v10, v68, v69
    v_cvt_pk_bf16_f32 v11, v70, v71
    buffer_store_dwordx4 v[8:11], v102, s[44:47], s86 offen sc1
    v_cvt_pk_bf16_f32 v12, v72, v73
    v_cvt_pk_bf16_f32 v13, v74, v75
    v_cvt_pk_bf16_f32 v14, v76, v77
    v_cvt_pk_bf16_f32 v15, v78, v79
    buffer_store_dwordx4 v[12:15], v102, s[44:47], s73 offen sc1
    v_cvt_pk_bf16_f32 v16, v80, v81
    v_cvt_pk_bf16_f32 v17, v82, v83
    v_cvt_pk_bf16_f32 v18, v84, v85
    v_cvt_pk_bf16_f32 v19, v86, v87
    buffer_store_dwordx4 v[16:19], v102, s[44:47], s74 offen sc1
    v_cvt_pk_bf16_f32 v20, v88, v89
    v_cvt_pk_bf16_f32 v21, v90, v91
    v_cvt_pk_bf16_f32 v22, v92, v93
    v_cvt_pk_bf16_f32 v23, v94, v95
    buffer_store_dwordx4 v[20:23], v102, s[44:47], s75 offen sc1
    s_waitcnt vmcnt(11)
    s_barrier
    s_waitcnt vmcnt(5)
    s_barrier
    s_xor_b32 s100, s88, 32768
    s_add_u32 m0, s101, 24576
    s_nop 0
    buffer_load_dwordx4 v96, s[48:51], s100 offen offset:0 lds
    buffer_load_dwordx4 v97, s[48:51], s100 offen offset:1024 lds
    buffer_load_dwordx4 v98, s[48:51], s100 offen offset:2048 lds
    buffer_load_dwordx4 v99, s[48:51], s100 offen offset:3072 lds
    ds_read_b128 v[128:131], v104 offset:0
    ds_read_b128 v[132:135], v104 offset:2048
    ds_read_b128 v[144:147], v105 offset:0
    ds_read_b128 v[148:151], v105 offset:2048
    s_waitcnt lgkmcnt(0)
    s_xor_b32 s100, s88, 0
    s_add_u32 m0, s101, 98304
    s_nop 0
    buffer_load_dwordx4 v96, s[52:55], s100 offen offset:0 lds
    buffer_load_dwordx4 v97, s[52:55], s100 offen offset:1024 lds
    buffer_load_dwordx4 v98, s[52:55], s100 offen offset:2048 lds
    buffer_load_dwordx4 v99, s[52:55], s100 offen offset:3072 lds
    s_waitcnt vmcnt(8)
    s_mov_b64 exec, 1
    buffer_store_dword v2, off, s[44:47], s87 offset:0 sc1
    s_mov_b64 exec, -1
    s_xor_b32 s100, s88, 32768
    s_add_u32 m0, s101, 0
    s_nop 0
    buffer_load_dwordx4 v96, s[52:55], s100 offen offset:0 lds
    buffer_load_dwordx4 v97, s[52:55], s100 offen offset:1024 lds
    buffer_load_dwordx4 v98, s[52:55], s100 offen offset:2048 lds
    buffer_load_dwordx4 v99, s[52:55], s100 offen offset:3072 lds
    s_waitcnt vmcnt(9)
    ds_read_b128 v[136:139], v100 offset:24576
    ds_read_b128 v[140:143], v100 offset:26624
    ds_read_b128 v[152:155], v101 offset:24576
    ds_read_b128 v[156:159], v101 offset:26624
    s_mul_i32 s73, s69, 142848
    s_mul_i32 s74, s65, 17664
    s_add_u32 s73, s73, s74
    s_add_u32 s73, s73, 0x600000
    v_add_u32 v6, s73, v1
    v_add_u32 v7, 71424, v6
    v_lshrrev_b32 v12, 4, v0
    v_and_b32 v13, 7, v0
    v_xor_b32 v12, v12, v13
    v_lshlrev_b32 v8, 4, v12
    v_bfe_u32 v12, v0, 3, 1
    v_and_b32 v13, 3, v0
    v_lshl_add_u32 v12, v12, 2, v13
    v_lshl_add_u32 v8, v12, 8, v8
    v_bfe_u32 v12, v0, 2, 1
    v_mul_u32_u24 v12, 16384, v12
    s_mul_i32 s73, s65, 4096
    s_add_u32 s73, s73, 98304
    v_add3_u32 v8, v8, v12, s73
    v_xor_b32 v9, 64, v8
    s_add_u32 s93, s93, 16384
    s_cmp_eq_u32 s93, s95
    s_cselect_b32 s93, s94, s93
    s_add_u32 s93, s93, 16384
    s_add_u32 s93, s93, 16384
    s_cmp_eq_u32 s93, s95
    s_cselect_b32 s93, s94, s93
    s_add_u32 s93, s93, 16384
    s_add_u32 s93, s93, 16384
    s_cmp_eq_u32 s93, s95
    s_cselect_b32 s93, s94, s93
    s_add_u32 s93, s93, 16384
    s_lshl_b32 s73, s69, 2
    s_add_u32 s73, s73, s65
    s_mul_i32 s73, s73, 64
    s_add_u32 s73, s73, 0xb22000
    v_mul_u32_u24 v12, 8, v0
    v_mov_b32 v5, v2
    s_waitcnt lgkmcnt(0)
    s_xor_b32 s100, s89, 0
    s_add_u32 m0, s101, 24576
    s_nop 0
    buffer_load_dwordx4 v96, s[48:51], s100 offen offset:0 lds
    buffer_load_dwordx4 v97, s[48:51], s100 offen offset:1024 lds
    buffer_load_dwordx4 v98, s[48:51], s100 offen offset:2048 lds
    buffer_load_dwordx4 v99, s[48:51], s100 offen offset:3072 lds
    s_waitcnt vmcnt(9)
    ds_read_b128 v[160:163], v104 offset:0
    ds_read_b128 v[164:167], v104 offset:2048
    ds_read_b128 v[176:179], v105 offset:0
    ds_read_b128 v[180:183], v105 offset:2048
    s_waitcnt lgkmcnt(0)
    s_xor_b32 s100, s89, 32768
    s_add_u32 m0, s101, 98304
    s_nop 0
    buffer_load_dwordx4 v96, s[48:51], s100 offen offset:0 lds
    buffer_load_dwordx4 v97, s[48:51], s100 offen offset:1024 lds
    buffer_load_dwordx4 v98, s[48:51], s100 offen offset:2048 lds
    buffer_load_dwordx4 v99, s[48:51], s100 offen offset:3072 lds
    s_waitcnt vmcnt(8)
    ds_read_b128 v[168:171], v100 offset:0
    ds_read_b128 v[172:175], v100 offset:2048
    ds_read_b128 v[184:187], v101 offset:0
    ds_read_b128 v[188:191], v101 offset:2048
    s_waitcnt lgkmcnt(0)
    s_xor_b32 s100, s89, 0
    s_add_u32 m0, s101, 0
    s_nop 0
    buffer_load_dwordx4 v96, s[52:55], s100 offen offset:0 lds
    buffer_load_dwordx4 v97, s[52:55], s100 offen offset:1024 lds
    buffer_load_dwordx4 v98, s[52:55], s100 offen offset:2048 lds
    buffer_load_dwordx4 v99, s[52:55], s100 offen offset:3072 lds
    s_waitcnt vmcnt(8)
    ds_read_b128 v[192:195], v100 offset:24576
    ds_read_b128 v[196:199], v100 offset:26624
    ds_read_b128 v[208:211], v101 offset:24576
    ds_read_b128 v[212:215], v101 offset:26624
    s_waitcnt lgkmcnt(0)
    s_xor_b32 s100, s89, 32768
    s_add_u32 m0, s101, 24576
    s_nop 0
    buffer_load_dwordx4 v96, s[52:55], s100 offen offset:0 lds
    buffer_load_dwordx4 v97, s[52:55], s100 offen offset:1024 lds
    buffer_load_dwordx4 v98, s[52:55], s100 offen offset:2048 lds
    buffer_load_dwordx4 v99, s[52:55], s100 offen offset:3072 lds
    s_waitcnt vmcnt(8)
    ds_read_b128 v[200:203], v104 offset:0
    ds_read_b128 v[204:207], v104 offset:2048
    ds_read_b128 v[216:219], v105 offset:0
    ds_read_b128 v[220:223], v105 offset:2048
    s_waitcnt lgkmcnt(0)
    s_add_u32 m0, s101, 98304
    s_add_u32 s93, s93, 16384
    s_cmp_eq_u32 s93, s95
    s_cselect_b32 s93, s94, s93
    buffer_load_dwordx4 v108, s[56:59], s93 offen offset:0 lds
    buffer_load_dwordx4 v109, s[56:59], s93 offen offset:1024 lds
    s_add_u32 m0, s101, 100352
    s_add_u32 s93, s93, 16384
    buffer_load_dwordx4 v108, s[56:59], s93 offen offset:0 lds
    buffer_load_dwordx4 v109, s[56:59], s93 offen offset:1024 lds
    s_waitcnt vmcnt(8)
    ds_read_b128 v[224:227], v100 offset:0
    ds_read_b128 v[228:231], v100 offset:2048
    ds_read_b128 v[240:243], v101 offset:0
    ds_read_b128 v[244:247], v101 offset:2048
    s_waitcnt lgkmcnt(0)
    s_add_u32 m0, s101, 0
    s_add_u32 s93, s93, 16384
    s_cmp_eq_u32 s93, s95
    s_cselect_b32 s93, s94, s93
    buffer_load_dwordx4 v108, s[56:59], s93 offen offset:0 lds
    buffer_load_dwordx4 v109, s[56:59], s93 offen offset:1024 lds
    s_add_u32 m0, s101, 2048
    s_add_u32 s93, s93, 16384
    buffer_load_dwordx4 v108, s[56:59], s93 offen offset:0 lds
    buffer_load_dwordx4 v109, s[56:59], s93 offen offset:1024 lds
    s_add_u32 m0, s101, 4096
    s_add_u32 s93, s93, 16384
    s_cmp_eq_u32 s93, s95
    s_cselect_b32 s93, s94, s93
    buffer_load_dwordx4 v108, s[56:59], s93 offen offset:0 lds
    buffer_load_dwordx4 v109, s[56:59], s93 offen offset:1024 lds
    s_waitcnt vmcnt(10)
    ds_read_b128 v[232:235], v100 offset:24576
    ds_read_b128 v[236:239], v100 offset:26624
    ds_read_b128 v[248:251], v101 offset:24576
    ds_read_b128 v[252:255], v101 offset:26624
    s_xor_b32 s93, s92, 0
    s_lshl_b32 s93, s93, 12
    s_xor_b32 s94, s92, 1
    s_lshl_b32 s94, s94, 12
    s_xor_b32 s95, s92, 2
    s_lshl_b32 s95, s95, 12
    s_xor_b32 s96, s92, 3
    s_lshl_b32 s96, s96, 12
    s_mov_b32 s56, s32
    s_mov_b32 s57, s33
    s_mov_b32 s58, 0x400000
    s_mov_b32 s59, 0x20000
    s_mov_b64 exec, 0xff
    buffer_load_dword v13, v12, s[44:47], s73 offen sc1
    s_mov_b64 exec, -1
    s_waitcnt vmcnt(1)
    s_mov_b64 exec, 1
    ds_add_u32 v117, v116 offset:68
    s_mov_b64 exec, -1
    s_waitcnt vmcnt(0)
    v_cmp_ne_u32 vcc, s71, v13
    s_nop 1
    s_and_b64 vcc, vcc, 0xff
    s_cbranch_scc1 L_pollH
L_pollH_out:
    buffer_load_dwordx4 v[16:19], v6, s[44:47], s93 offen offset:0 sc1
    buffer_load_dwordx4 v[20:23], v6, s[44:47], s93 offen offset:2048 sc1
    buffer_load_dwordx4 v[24:27], v6, s[44:47], s93 offen offset:1024 sc1
    buffer_load_dwordx4 v[28:31], v6, s[44:47], s93 offen offset:3072 sc1
    buffer_load_dwordx4 v[32:35], v7, s[44:47], s93 offen offset:0 sc1
    buffer_load_dwordx4 v[36:39], v7, s[44:47], s93 offen offset:2048 sc1
    buffer_load_dwordx4 v[40:43], v7, s[44:47], s93 offen offset:1024 sc1
    buffer_load_dwordx4 v[44:47], v7, s[44:47], s93 offen offset:3072 sc1
    buffer_load_dwordx4 v[48:51], v6, s[44:47], s94 offen offset:0 sc1
    buffer_load_dwordx4 v[52:55], v6, s[44:47], s94 offen offset:2048 sc1
    s_waitcnt lgkmcnt(0)
    s_lshl_b32 s73, s69, 6
    s_add_u32 s73, s73, s65
    v_lshrrev_b32 v15, 5, v0
    v_bfe_u32 v13, v0, 3, 1
    v_xor_b32 v15, v15, v13
    v_bfe_u32 v3, v0, 4, 1
    v_lshl_add_u32 v12, v3, 1, v15
    v_lshl_add_u32 v13, v15, 4, s73
    v_lshl_add_u32 v13, v3, 2, v13
    v_and_b32 v14, 15, v0
    s_lshl_b32 s74, s70, 7
    v_lshl_add_u32 v1, v14, 3, s74
    v_lshl_add_u32 v2, v13, 10, v1
    v_lshlrev_b32 v4, 2, v13
    v_add_u32 v4, 0xb20000, v4
    s_lshl_b32 s75, s65, 8
    s_add_u32 s74, s75, 98304
    v_lshl_add_u32 v3, v3, 10, s74
    v_lshl_add_u32 v3, v15, 14, v3
    v_lshl_or_b32 v13, v15, 2, s65
    v_xor_b32 v13, v13, v14
    v_lshl_add_u32 v3, v13, 4, v3
    v_lshl_add_u32 v12, v12, 6, s75
    v_lshrrev_b32 v13, 2, v14
    v_lshl_add_u32 v12, v13, 10, v12
    v_and_b32 v13, 3, v0
    v_lshl_add_u32 v14, v13, 4, v12
    v_add_u32 v15, 49152, v14
    s_lshl_b32 s73, s80, 7
    v_xor_b32 v8, s73, v8
    v_xor_b32 v10, 0x80, v8
    v_xor_b32 v9, s73, v9
    v_xor_b32 v11, 0x80, v9
    s_waitcnt vmcnt(8)
    v_mfma_f32_16x16x32_bf16 v[64:67], v[128:131], v[16:19], 0
    buffer_load_dwordx4 v[56:59], v6, s[44:47], s94 offen offset:1024 sc1
    v_mfma_f32_16x16x32_bf16 v[64:67], v[144:147], v[20:23], v[64:67]
    v_mfma_f32_16x16x32_bf16 v[68:71], v[148:151], v[20:23], 0
    v_mfma_f32_16x16x32_bf16 v[68:71], v[132:135], v[16:19], v[68:71]
    v_mfma_f32_16x16x32_bf16 v[72:75], v[136:139], v[16:19], 0
    buffer_load_dwordx4 v[60:63], v6, s[44:47], s94 offen offset:3072 sc1
    v_mfma_f32_16x16x32_bf16 v[72:75], v[152:155], v[20:23], v[72:75]
    v_mfma_f32_16x16x32_bf16 v[76:79], v[156:159], v[20:23], 0
    v_mfma_f32_16x16x32_bf16 v[76:79], v[140:143], v[16:19], v[76:79]
    s_waitcnt vmcnt(8)
    v_mfma_f32_16x16x32_bf16 v[92:95], v[140:143], v[24:27], 0
    buffer_load_dwordx4 v[16:19], v7, s[44:47], s94 offen offset:0 sc1
    v_mfma_f32_16x16x32_bf16 v[92:95], v[156:159], v[28:31], v[92:95]
    v_mfma_f32_16x16x32_bf16 v[88:91], v[152:155], v[28:31], 0
    v_mfma_f32_16x16x32_bf16 v[88:91], v[136:139], v[24:27], v[88:91]
    v_mfma_f32_16x16x32_bf16 v[84:87], v[132:135], v[24:27], 0
    buffer_load_dwordx4 v[20:23], v7, s[44:47], s94 offen offset:2048 sc1
    v_mfma_f32_16x16x32_bf16 v[84:87], v[148:151], v[28:31], v[84:87]
    v_mfma_f32_16x16x32_bf16 v[80:83], v[144:147], v[28:31], 0
    v_mfma_f32_16x16x32_bf16 v[80:83], v[128:131], v[24:27], v[80:83]
    s_waitcnt vmcnt(8)
    v_mfma_f32_16x16x32_bf16 v[96:99], v[128:131], v[32:35], 0
    buffer_load_dwordx4 v[24:27], v7, s[44:47], s94 offen offset:1024 sc1
    v_mfma_f32_16x16x32_bf16 v[96:99], v[144:147], v[36:39], v[96:99]
    v_mfma_f32_16x16x32_bf16 v[100:103], v[148:151], v[36:39], 0
    v_mfma_f32_16x16x32_bf16 v[100:103], v[132:135], v[32:35], v[100:103]
    v_mfma_f32_16x16x32_bf16 v[104:107], v[136:139], v[32:35], 0
    buffer_load_dwordx4 v[28:31], v7, s[44:47], s94 offen offset:3072 sc1
    v_mfma_f32_16x16x32_bf16 v[104:107], v[152:155], v[36:39], v[104:107]
    v_mfma_f32_16x16x32_bf16 v[108:111], v[156:159], v[36:39], 0
    v_mfma_f32_16x16x32_bf16 v[108:111], v[140:143], v[32:35], v[108:111]
    s_waitcnt vmcnt(8)
    v_mfma_f32_16x16x32_bf16 v[124:127], v[140:143], v[40:43], 0
    buffer_load_dwordx4 v[32:35], v6, s[44:47], s95 offen offset:0 sc1
    v_mfma_f32_16x16x32_bf16 v[124:127], v[156:159], v[44:47], v[124:127]
    v_mfma_f32_16x16x32_bf16 v[120:123], v[152:155], v[44:47], 0
    v_mfma_f32_16x16x32_bf16 v[120:123], v[136:139], v[40:43], v[120:123]
    v_mfma_f32_16x16x32_bf16 v[116:119], v[132:135], v[40:43], 0
    buffer_load_dwordx4 v[36:39], v6, s[44:47], s95 offen offset:2048 sc1
    v_mfma_f32_16x16x32_bf16 v[116:119], v[148:151], v[44:47], v[116:119]
    v_mfma_f32_16x16x32_bf16 v[112:115], v[144:147], v[44:47], 0
    v_mfma_f32_16x16x32_bf16 v[112:115], v[128:131], v[40:43], v[112:115]
    s_waitcnt vmcnt(8)
    v_mfma_f32_16x16x32_bf16 v[64:67], v[160:163], v[48:51], v[64:67]
    buffer_load_dwordx4 v[40:43], v6, s[44:47], s95 offen offset:1024 sc1
    v_mfma_f32_16x16x32_bf16 v[64:67], v[176:179], v[52:55], v[64:67]
    v_mfma_f32_16x16x32_bf16 v[68:71], v[180:183], v[52:55], v[68:71]
    v_mfma_f32_16x16x32_bf16 v[68:71], v[164:167], v[48:51], v[68:71]
    global_load_dwordx2 v[136:137], v1, s[20:21]
    s_mov_b32 s75, 0
    buffer_load_dwordx2 v[128:129], v2, s[40:43], s75 offen
    s_mov_b32 s75, 8192
    buffer_load_dwordx2 v[130:131], v2, s[40:43], s75 offen
    s_mov_b32 s75, 32768
    buffer_load_dwordx2 v[132:133], v2, s[40:43], s75 offen
    s_mov_b32 s75, 40960
    buffer_load_dwordx2 v[134:135], v2, s[40:43], s75 offen
    v_mfma_f32_16x16x32_bf16 v[72:75], v[168:171], v[48:51], v[72:75]
    buffer_load_dwordx4 v[44:47], v6, s[44:47], s95 offen offset:3072 sc1
    v_mfma_f32_16x16x32_bf16 v[72:75], v[184:187], v[52:55], v[72:75]
    v_mfma_f32_16x16x32_bf16 v[76:79], v[188:191], v[52:55], v[76:79]
    v_mfma_f32_16x16x32_bf16 v[76:79], v[172:175], v[48:51], v[76:79]
    s_waitcnt vmcnt(13)
    v_mfma_f32_16x16x32_bf16 v[92:95], v[172:175], v[56:59], v[92:95]
    buffer_load_dwordx4 v[48:51], v7, s[44:47], s95 offen offset:0 sc1
    v_mfma_f32_16x16x32_bf16 v[92:95], v[188:191], v[60:63], v[92:95]
    v_mfma_f32_16x16x32_bf16 v[88:91], v[184:187], v[60:63], v[88:91]
    v_mfma_f32_16x16x32_bf16 v[88:91], v[168:171], v[56:59], v[88:91]
    v_mfma_f32_16x16x32_bf16 v[84:87], v[164:167], v[56:59], v[84:87]
    buffer_load_dwordx4 v[52:55], v7, s[44:47], s95 offen offset:2048 sc1
    v_mfma_f32_16x16x32_bf16 v[84:87], v[180:183], v[60:63], v[84:87]
    v_mfma_f32_16x16x32_bf16 v[80:83], v[176:179], v[60:63], v[80:83]
    v_mfma_f32_16x16x32_bf16 v[80:83], v[160:163], v[56:59], v[80:83]
    s_barrier
    s_waitcnt vmcnt(13)
    v_mfma_f32_16x16x32_bf16 v[96:99], v[160:163], v[16:19], v[96:99]
    buffer_load_dwordx4 v[56:59], v7, s[44:47], s95 offen offset:1024 sc1
    v_mfma_f32_16x16x32_bf16 v[96:99], v[176:179], v[20:23], v[96:99]
    v_mfma_f32_16x16x32_bf16 v[100:103], v[180:183], v[20:23], v[100:103]
    v_mfma_f32_16x16x32_bf16 v[100:103], v[164:167], v[16:19], v[100:103]
    buffer_load_dword v138, v4, s[44:47], 0 offen offset:0 sc1
    buffer_load_dword v139, v4, s[44:47], 0 offen offset:32 sc1
    buffer_load_dword v140, v4, s[44:47], 0 offen offset:128 sc1
    buffer_load_dword v141, v4, s[44:47], 0 offen offset:160 sc1
    v_mfma_f32_16x16x32_bf16 v[104:107], v[168:171], v[16:19], v[104:107]
    buffer_load_dwordx4 v[60:63], v7, s[44:47], s95 offen offset:3072 sc1
    v_mfma_f32_16x16x32_bf16 v[104:107], v[184:187], v[20:23], v[104:107]
    v_mfma_f32_16x16x32_bf16 v[108:111], v[188:191], v[20:23], v[108:111]
    v_mfma_f32_16x16x32_bf16 v[108:111], v[172:175], v[16:19], v[108:111]
    s_waitcnt vmcnt(17)
    v_mfma_f32_16x16x32_bf16 v[124:127], v[172:175], v[24:27], v[124:127]
    buffer_load_dwordx4 v[16:19], v6, s[44:47], s96 offen offset:0 sc1
    v_mfma_f32_16x16x32_bf16 v[124:127], v[188:191], v[28:31], v[124:127]
    v_mfma_f32_16x16x32_bf16 v[120:123], v[184:187], v[28:31], v[120:123]
    v_mfma_f32_16x16x32_bf16 v[120:123], v[168:171], v[24:27], v[120:123]
    v_mfma_f32_16x16x32_bf16 v[116:119], v[164:167], v[24:27], v[116:119]
    buffer_load_dwordx4 v[20:23], v6, s[44:47], s96 offen offset:2048 sc1
    v_mfma_f32_16x16x32_bf16 v[116:119], v[180:183], v[28:31], v[116:119]
    v_mfma_f32_16x16x32_bf16 v[112:115], v[176:179], v[28:31], v[112:115]
    v_mfma_f32_16x16x32_bf16 v[112:115], v[160:163], v[24:27], v[112:115]
    s_waitcnt vmcnt(17)
    v_mfma_f32_16x16x32_bf16 v[64:67], v[192:195], v[32:35], v[64:67]
    buffer_load_dwordx4 v[24:27], v6, s[44:47], s96 offen offset:1024 sc1
    v_mfma_f32_16x16x32_bf16 v[64:67], v[208:211], v[36:39], v[64:67]
    v_mfma_f32_16x16x32_bf16 v[68:71], v[212:215], v[36:39], v[68:71]
    v_mfma_f32_16x16x32_bf16 v[68:71], v[196:199], v[32:35], v[68:71]
    v_mfma_f32_16x16x32_bf16 v[72:75], v[200:203], v[32:35], v[72:75]
    buffer_load_dwordx4 v[28:31], v6, s[44:47], s96 offen offset:3072 sc1
    v_mfma_f32_16x16x32_bf16 v[72:75], v[216:219], v[36:39], v[72:75]
    v_mfma_f32_16x16x32_bf16 v[76:79], v[220:223], v[36:39], v[76:79]
    v_mfma_f32_16x16x32_bf16 v[76:79], v[204:207], v[32:35], v[76:79]
    s_waitcnt vmcnt(12)
    v_mfma_f32_16x16x32_bf16 v[92:95], v[204:207], v[40:43], v[92:95]
    buffer_load_dwordx4 v[32:35], v7, s[44:47], s96 offen offset:0 sc1
    v_mfma_f32_16x16x32_bf16 v[92:95], v[220:223], v[44:47], v[92:95]
    v_mfma_f32_16x16x32_bf16 v[88:91], v[216:219], v[44:47], v[88:91]
    v_mfma_f32_16x16x32_bf16 v[88:91], v[200:203], v[40:43], v[88:91]
    v_mfma_f32_16x16x32_bf16 v[84:87], v[196:199], v[40:43], v[84:87]
    buffer_load_dwordx4 v[36:39], v7, s[44:47], s96 offen offset:2048 sc1
    v_mfma_f32_16x16x32_bf16 v[84:87], v[212:215], v[44:47], v[84:87]
    v_mfma_f32_16x16x32_bf16 v[80:83], v[208:211], v[44:47], v[80:83]
    v_mfma_f32_16x16x32_bf16 v[80:83], v[192:195], v[40:43], v[80:83]
    s_waitcnt vmcnt(12)
    v_mfma_f32_16x16x32_bf16 v[96:99], v[192:195], v[48:51], v[96:99]
    buffer_load_dwordx4 v[40:43], v7, s[44:47], s96 offen offset:1024 sc1
    v_mfma_f32_16x16x32_bf16 v[96:99], v[208:211], v[52:55], v[96:99]
    v_mfma_f32_16x16x32_bf16 v[100:103], v[212:215], v[52:55], v[100:103]
    v_mfma_f32_16x16x32_bf16 v[100:103], v[196:199], v[48:51], v[100:103]
    v_mfma_f32_16x16x32_bf16 v[104:107], v[200:203], v[48:51], v[104:107]
    buffer_load_dwordx4 v[44:47], v7, s[44:47], s96 offen offset:3072 sc1
    v_mfma_f32_16x16x32_bf16 v[104:107], v[216:219], v[52:55], v[104:107]
    v_mfma_f32_16x16x32_bf16 v[108:111], v[220:223], v[52:55], v[108:111]
    v_mfma_f32_16x16x32_bf16 v[108:111], v[204:207], v[48:51], v[108:111]
    s_waitcnt vmcnt(8)
    v_mfma_f32_16x16x32_bf16 v[124:127], v[204:207], v[56:59], v[124:127]
    v_mfma_f32_16x16x32_bf16 v[124:127], v[220:223], v[60:63], v[124:127]
    v_mfma_f32_16x16x32_bf16 v[120:123], v[216:219], v[60:63], v[120:123]
    v_mfma_f32_16x16x32_bf16 v[120:123], v[200:203], v[56:59], v[120:123]
    v_mfma_f32_16x16x32_bf16 v[116:119], v[196:199], v[56:59], v[116:119]
    v_mfma_f32_16x16x32_bf16 v[116:119], v[212:215], v[60:63], v[116:119]
    v_mfma_f32_16x16x32_bf16 v[112:115], v[208:211], v[60:63], v[112:115]
    v_mfma_f32_16x16x32_bf16 v[112:115], v[192:195], v[56:59], v[112:115]
    s_waitcnt vmcnt(6)
    v_mfma_f32_16x16x32_bf16 v[64:67], v[224:227], v[16:19], v[64:67]
    v_mfma_f32_16x16x32_bf16 v[64:67], v[240:243], v[20:23], v[64:67]
    v_mfma_f32_16x16x32_bf16 v[68:71], v[244:247], v[20:23], v[68:71]
    v_mfma_f32_16x16x32_bf16 v[68:71], v[228:231], v[16:19], v[68:71]
    v_mfma_f32_16x16x32_bf16 v[72:75], v[232:235], v[16:19], v[72:75]
    v_mfma_f32_16x16x32_bf16 v[72:75], v[248:251], v[20:23], v[72:75]
    v_mfma_f32_16x16x32_bf16 v[76:79], v[252:255], v[20:23], v[76:79]
    v_mfma_f32_16x16x32_bf16 v[76:79], v[236:239], v[16:19], v[76:79]
    s_waitcnt vmcnt(4)
    v_mfma_f32_16x16x32_bf16 v[92:95], v[236:239], v[24:27], v[92:95]
    v_mfma_f32_16x16x32_bf16 v[92:95], v[252:255], v[28:31], v[92:95]
    v_mfma_f32_16x16x32_bf16 v[88:91], v[248:251], v[28:31], v[88:91]
    v_mfma_f32_16x16x32_bf16 v[88:91], v[232:235], v[24:27], v[88:91]
    v_mfma_f32_16x16x32_bf16 v[84:87], v[228:231], v[24:27], v[84:87]
    v_mfma_f32_16x16x32_bf16 v[84:87], v[244:247], v[28:31], v[84:87]
    v_mfma_f32_16x16x32_bf16 v[80:83], v[240:243], v[28:31], v[80:83]
    v_mfma_f32_16x16x32_bf16 v[80:83], v[224:227], v[24:27], v[80:83]
    s_waitcnt vmcnt(2)
    v_mfma_f32_16x16x32_bf16 v[96:99], v[224:227], v[32:35], v[96:99]
    v_mfma_f32_16x16x32_bf16 v[96:99], v[240:243], v[36:39], v[96:99]
    v_mfma_f32_16x16x32_bf16 v[100:103], v[244:247], v[36:39], v[100:103]
    v_mfma_f32_16x16x32_bf16 v[100:103], v[228:231], v[32:35], v[100:103]
    v_mfma_f32_16x16x32_bf16 v[104:107], v[232:235], v[32:35], v[104:107]
    v_mfma_f32_16x16x32_bf16 v[104:107], v[248:251], v[36:39], v[104:107]
    v_mfma_f32_16x16x32_bf16 v[108:111], v[252:255], v[36:39], v[108:111]
    v_mfma_f32_16x16x32_bf16 v[108:111], v[236:239], v[32:35], v[108:111]
    s_waitcnt vmcnt(0)
    v_mfma_f32_16x16x32_bf16 v[124:127], v[236:239], v[40:43], v[124:127]
    v_mfma_f32_16x16x32_bf16 v[124:127], v[252:255], v[44:47], v[124:127]
    v_mfma_f32_16x16x32_bf16 v[120:123], v[248:251], v[44:47], v[120:123]
    v_mfma_f32_16x16x32_bf16 v[120:123], v[232:235], v[40:43], v[120:123]
    v_mfma_f32_16x16x32_bf16 v[116:119], v[228:231], v[40:43], v[116:119]
    v_mfma_f32_16x16x32_bf16 v[116:119], v[244:247], v[44:47], v[116:119]
    v_mfma_f32_16x16x32_bf16 v[112:115], v[240:243], v[44:47], v[112:115]
    v_mfma_f32_16x16x32_bf16 v[112:115], v[224:227], v[40:43], v[112:115]
    v_mov_b32 v12, 77824
    v_mov_b32 v13, 1
    v_lshlrev_b32 v2, 1, v2
    ds_write_b128 v8, v[64:67] offset:0
    ds_write_b128 v9, v[68:71] offset:0
    ds_write_b128 v10, v[72:75] offset:0
    ds_write_b128 v11, v[76:79] offset:0
    ds_write_b128 v8, v[80:83] offset:2048
    ds_write_b128 v9, v[84:87] offset:2048
    ds_write_b128 v10, v[88:91] offset:2048
    ds_write_b128 v11, v[92:95] offset:2048
    ds_write_b128 v8, v[96:99] offset:32768
    ds_write_b128 v9, v[100:103] offset:32768
    ds_write_b128 v10, v[104:107] offset:32768
    ds_write_b128 v11, v[108:111] offset:32768
    ds_write_b128 v8, v[112:115] offset:34816
    ds_write_b128 v9, v[116:119] offset:34816
    ds_write_b128 v10, v[120:123] offset:34816
    ds_write_b128 v11, v[124:127] offset:34816
    s_mov_b64 exec, 1
    ds_add_u32 v12, v13 offset:0
    s_mov_b64 exec, -1
    v_lshlrev_b32 v160, 16, v136
    v_and_b32 v161, 0xffff0000, v136
    v_lshlrev_b32 v162, 16, v137
    v_and_b32 v163, 0xffff0000, v137
    v_lshlrev_b32 v12, 16, v128
    v_and_b32 v13, 0xffff0000, v128
    v_mul_f32 v12, v12, v160
    v_mul_f32 v13, v13, v161
    v_cvt_pk_bf16_f32 v13, v12, v13
    v_lshlrev_b32 v144, 16, v13
    v_and_b32 v145, 0xffff0000, v13
    v_lshlrev_b32 v12, 16, v129
    v_and_b32 v13, 0xffff0000, v129
    v_mul_f32 v12, v12, v162
    v_mul_f32 v13, v13, v163
    v_cvt_pk_bf16_f32 v13, v12, v13
    v_lshlrev_b32 v146, 16, v13
    v_and_b32 v147, 0xffff0000, v13
    v_lshlrev_b32 v12, 16, v130
    v_and_b32 v13, 0xffff0000, v130
    v_mul_f32 v12, v12, v160
    v_mul_f32 v13, v13, v161
    v_cvt_pk_bf16_f32 v13, v12, v13
    v_lshlrev_b32 v148, 16, v13
    v_and_b32 v149, 0xffff0000, v13
    v_lshlrev_b32 v12, 16, v131
    v_and_b32 v13, 0xffff0000, v131
    v_mul_f32 v12, v12, v162
    v_mul_f32 v13, v13, v163
    v_cvt_pk_bf16_f32 v13, v12, v13
    v_lshlrev_b32 v150, 16, v13
    v_and_b32 v151, 0xffff0000, v13
    v_lshlrev_b32 v12, 16, v132
    v_and_b32 v13, 0xffff0000, v132
    v_mul_f32 v12, v12, v160
    v_mul_f32 v13, v13, v161
    v_cvt_pk_bf16_f32 v13, v12, v13
    v_lshlrev_b32 v152, 16, v13
    v_and_b32 v153, 0xffff0000, v13
    v_lshlrev_b32 v12, 16, v133
    v_and_b32 v13, 0xffff0000, v133
    v_mul_f32 v12, v12, v162
    v_mul_f32 v13, v13, v163
    v_cvt_pk_bf16_f32 v13, v12, v13
    v_lshlrev_b32 v154, 16, v13
    v_and_b32 v155, 0xffff0000, v13
    v_lshlrev_b32 v12, 16, v134
    v_and_b32 v13, 0xffff0000, v134
    v_mul_f32 v12, v12, v160
    v_mul_f32 v13, v13, v161
    v_cvt_pk_bf16_f32 v13, v12, v13
    v_lshlrev_b32 v156, 16, v13
    v_and_b32 v157, 0xffff0000, v13
    v_lshlrev_b32 v12, 16, v135
    v_and_b32 v13, 0xffff0000, v135
    v_mul_f32 v12, v12, v162
    v_mul_f32 v13, v13, v163
    v_cvt_pk_bf16_f32 v13, v12, v13
    v_lshlrev_b32 v158, 16, v13
    v_and_b32 v159, 0xffff0000, v13
    v_mov_b32 v12, 77824
    v_mov_b32 v13, 1
    v_sub_f32 v164, 1.0, v138
    v_cvt_pk_bf16_f32 v164, v164, v164
    v_lshlrev_b32 v164, 16, v164
    v_sub_f32 v165, 1.0, v139
    v_cvt_pk_bf16_f32 v165, v165, v165
    v_lshlrev_b32 v165, 16, v165
    v_sub_f32 v166, 1.0, v140
    v_cvt_pk_bf16_f32 v166, v166, v166
    v_lshlrev_b32 v166, 16, v166
    v_sub_f32 v167, 1.0, v141
    v_cvt_pk_bf16_f32 v167, v167, v167
    v_lshlrev_b32 v167, 16, v167
    s_mov_b32 s75, 0
    s_mov_b32 s76, 16384
    s_mov_b32 s77, 65536
    s_mov_b32 s78, 81920
    s_lshl_b32 s73, s70, 5
    s_add_u32 s73, s73, s69
    s_lshl_b32 s74, s65, 8
    s_add_u32 s73, s73, s74
    s_cmp_eq_u32 s73, 31
    s_cselect_b32 s73, 0xb48000, s46
    s_mov_b64 exec, 1
    buffer_store_dword v5, off, s[44:47], s73 offset:0 sc1
    s_mov_b64 exec, -1
    ds_read_b32 v16, v12 offset:0
    s_waitcnt lgkmcnt(0)
    v_cmp_ne_u32 vcc, 4, v16
    s_nop 1
    s_cbranch_vccnz L_spinM
L_spinM_out:
    ds_read_b128 v[64:67], v3 offset:0
    ds_read_b128 v[68:71], v3 offset:4096
    ds_read_b128 v[72:75], v3 offset:8192
    ds_read_b128 v[76:79], v3 offset:12288
    ds_read_b128 v[80:83], v3 offset:2048
    ds_read_b128 v[84:87], v3 offset:6144
    ds_read_b128 v[88:91], v3 offset:10240
    ds_read_b128 v[92:95], v3 offset:14336
    ds_read_b128 v[96:99], v3 offset:32768
    ds_read_b128 v[100:103], v3 offset:36864
    ds_read_b128 v[104:107], v3 offset:40960
    ds_read_b128 v[108:111], v3 offset:45056
    ds_read_b128 v[112:115], v3 offset:34816
    ds_read_b128 v[116:119], v3 offset:38912
    ds_read_b128 v[120:123], v3 offset:43008
    ds_read_b128 v[124:127], v3 offset:47104
    s_waitcnt lgkmcnt(12)
    v_add_f32 v64, v64, v68
    v_add_f32 v72, v72, v76
    v_add_f32 v65, v65, v69
    v_add_f32 v73, v73, v77
    v_add_f32 v66, v66, v70
    v_add_f32 v74, v74, v78
    v_add_f32 v67, v67, v71
    v_add_f32 v75, v75, v79
    v_add_f32 v64, v64, v72
    v_add_f32 v65, v65, v73
    v_add_f32 v66, v66, v74
    v_add_f32 v67, v67, v75
    v_add_f32 v64, v64, v144
    v_add_f32 v65, v65, v145
    v_add_f32 v66, v66, v146
    v_add_f32 v67, v67, v147
    v_mul_f32 v144, v138, v64
    v_mul_f32 v145, v138, v65
    v_mul_f32 v146, v138, v66
    v_mul_f32 v147, v138, v67
    s_waitcnt lgkmcnt(8)
    v_add_f32 v80, v80, v84
    v_add_f32 v88, v88, v92
    v_add_f32 v81, v81, v85
    v_add_f32 v89, v89, v93
    v_add_f32 v82, v82, v86
    v_add_f32 v90, v90, v94
    v_add_f32 v83, v83, v87
    v_add_f32 v91, v91, v95
    v_add_f32 v80, v80, v88
    v_add_f32 v81, v81, v89
    v_add_f32 v82, v82, v90
    v_add_f32 v83, v83, v91
    v_add_f32 v80, v80, v148
    v_add_f32 v81, v81, v149
    v_add_f32 v82, v82, v150
    v_add_f32 v83, v83, v151
    v_mul_f32 v148, v139, v80
    v_mul_f32 v149, v139, v81
    v_mul_f32 v150, v139, v82
    v_mul_f32 v151, v139, v83
    s_waitcnt lgkmcnt(4)
    v_add_f32 v96, v96, v100
    v_add_f32 v104, v104, v108
    v_add_f32 v97, v97, v101
    v_add_f32 v105, v105, v109
    v_add_f32 v98, v98, v102
    v_add_f32 v106, v106, v110
    v_add_f32 v99, v99, v103
    v_add_f32 v107, v107, v111
    v_add_f32 v96, v96, v104
    v_add_f32 v97, v97, v105
    v_add_f32 v98, v98, v106
    v_add_f32 v99, v99, v107
    v_add_f32 v96, v96, v152
    v_add_f32 v97, v97, v153
    v_add_f32 v98, v98, v154
    v_add_f32 v99, v99, v155
    v_mul_f32 v152, v140, v96
    v_mul_f32 v153, v140, v97
    v_mul_f32 v154, v140, v98
    v_mul_f32 v155, v140, v99
    s_waitcnt lgkmcnt(0)
    v_add_f32 v112, v112, v116
    v_add_f32 v120, v120, v124
    v_add_f32 v113, v113, v117
    v_add_f32 v121, v121, v125
    v_add_f32 v114, v114, v118
    v_add_f32 v122, v122, v126
    v_add_f32 v115, v115, v119
    v_add_f32 v123, v123, v127
    v_add_f32 v112, v112, v120
    v_add_f32 v113, v113, v121
    v_add_f32 v114, v114, v122
    v_add_f32 v115, v115, v123
    v_add_f32 v112, v112, v156
    v_add_f32 v113, v113, v157
    v_add_f32 v114, v114, v158
    v_add_f32 v115, v115, v159
    v_mul_f32 v156, v141, v112
    v_mul_f32 v157, v141, v113
    v_mul_f32 v158, v141, v114
    v_mul_f32 v159, v141, v115
    s_barrier
    ds_read_b128 v[64:67], v14 offset:0
    ds_read_b128 v[68:71], v14 offset:6144
    ds_read_b128 v[72:75], v14 offset:12288
    ds_read_b128 v[76:79], v14 offset:18432
    s_waitcnt lgkmcnt(2)
    v_add_f32 v64, v64, v68
    v_add_f32 v65, v65, v69
    v_add_f32 v66, v66, v70
    v_add_f32 v67, v67, v71
    s_waitcnt lgkmcnt(0)
    v_add_f32 v72, v72, v76
    v_add_f32 v73, v73, v77
    v_add_f32 v74, v74, v78
    v_add_f32 v75, v75, v79
    v_add_f32 v64, v64, v72
    v_add_f32 v65, v65, v73
    v_add_f32 v66, v66, v74
    v_add_f32 v67, v67, v75
    v_fma_f32 v64, v164, v64, v144
    v_fma_f32 v65, v164, v65, v145
    v_fma_f32 v66, v164, v66, v146
    v_fma_f32 v67, v164, v67, v147
    buffer_store_dwordx4 v[64:67], v2, s[56:59], s75 offen sc1 nt
    s_barrier
    ds_read_b128 v[80:83], v14 offset:24576
    ds_read_b128 v[84:87], v14 offset:30720
    ds_read_b128 v[88:91], v14 offset:36864
    ds_read_b128 v[92:95], v14 offset:43008
    s_waitcnt lgkmcnt(2)
    v_add_f32 v80, v80, v84
    v_add_f32 v81, v81, v85
    v_add_f32 v82, v82, v86
    v_add_f32 v83, v83, v87
    s_waitcnt lgkmcnt(0)
    v_add_f32 v88, v88, v92
    v_add_f32 v89, v89, v93
    v_add_f32 v90, v90, v94
    v_add_f32 v91, v91, v95
    v_add_f32 v80, v80, v88
    v_add_f32 v81, v81, v89
    v_add_f32 v82, v82, v90
    v_add_f32 v83, v83, v91
    v_fma_f32 v80, v165, v80, v148
    v_fma_f32 v81, v165, v81, v149
    v_fma_f32 v82, v165, v82, v150
    v_fma_f32 v83, v165, v83, v151
    buffer_store_dwordx4 v[80:83], v2, s[56:59], s76 offen sc1 nt
    s_barrier
    ds_read_b128 v[96:99], v15 offset:0
    ds_read_b128 v[100:103], v15 offset:6144
    ds_read_b128 v[104:107], v15 offset:12288
    ds_read_b128 v[108:111], v15 offset:18432
    s_waitcnt lgkmcnt(2)
    v_add_f32 v96, v96, v100
    v_add_f32 v97, v97, v101
    v_add_f32 v98, v98, v102
    v_add_f32 v99, v99, v103
    s_waitcnt lgkmcnt(0)
    v_add_f32 v104, v104, v108
    v_add_f32 v105, v105, v109
    v_add_f32 v106, v106, v110
    v_add_f32 v107, v107, v111
    v_add_f32 v96, v96, v104
    v_add_f32 v97, v97, v105
    v_add_f32 v98, v98, v106
    v_add_f32 v99, v99, v107
    v_fma_f32 v96, v166, v96, v152
    v_fma_f32 v97, v166, v97, v153
    v_fma_f32 v98, v166, v98, v154
    v_fma_f32 v99, v166, v99, v155
    buffer_store_dwordx4 v[96:99], v2, s[56:59], s77 offen sc1 nt
    s_barrier
    ds_read_b128 v[112:115], v15 offset:24576
    ds_read_b128 v[116:119], v15 offset:30720
    ds_read_b128 v[120:123], v15 offset:36864
    ds_read_b128 v[124:127], v15 offset:43008
    s_waitcnt lgkmcnt(2)
    v_pk_add_f32 v[112:113], v[112:113], v[116:117]
    v_pk_add_f32 v[114:115], v[114:115], v[118:119]
    s_waitcnt lgkmcnt(0)
    v_pk_add_f32 v[120:121], v[120:121], v[124:125]
    v_pk_add_f32 v[122:123], v[122:123], v[126:127]
    v_pk_add_f32 v[112:113], v[112:113], v[120:121]
    v_pk_add_f32 v[114:115], v[114:115], v[122:123]
    v_fma_f32 v112, v167, v112, v156
    v_fma_f32 v113, v167, v113, v157
    v_fma_f32 v114, v167, v114, v158
    v_fma_f32 v115, v167, v115, v159
    buffer_store_dwordx4 v[112:115], v2, s[56:59], s78 offen sc1 nt
    s_endpgm
L_pollE:
    s_mov_b32 s97, 0
L_pollE_l:
    s_sleep 4
    v_subrev_u32 v4, -1, v114
    v_cmp_le_i32 vcc, 2, v4
    v_lshl_add_u32 v4, v4, 9, v120
    s_nop 0
    v_cndmask_b32 v4, v112, v4, vcc
    buffer_load_dwordx4 v[224:227], v4, s[44:47], s91 offen sc1
    v_subrev_u32 v4, 0, v114
    v_cmp_le_i32 vcc, 2, v4
    v_lshl_add_u32 v4, v4, 9, v120
    s_nop 0
    v_cndmask_b32 v4, v112, v4, vcc
    buffer_load_dwordx4 v[228:231], v4, s[44:47], s91 offen sc1
    v_subrev_u32 v4, 1, v114
    v_cmp_le_i32 vcc, 2, v4
    v_lshl_add_u32 v4, v4, 9, v120
    s_nop 0
    v_cndmask_b32 v4, v112, v4, vcc
    buffer_load_dwordx4 v[232:235], v4, s[44:47], s91 offen sc1
    v_subrev_u32 v4, 2, v114
    v_cmp_le_i32 vcc, 2, v4
    v_lshl_add_u32 v4, v4, 9, v120
    s_nop 0
    v_cndmask_b32 v4, v112, v4, vcc
    buffer_load_dwordx4 v[236:239], v4, s[44:47], s91 offen sc1
    s_add_u32 s97, s97, 1
    s_cmp_gt_u32 s97, 200000
    s_waitcnt vmcnt(0)
    s_cbranch_scc1 L_pollE_out
    v_add3_u32 v4, v226, v230, v234
    v_add_u32 v4, v4, v238
    v_cmp_ne_u32 vcc, v4, v115
    s_nop 1
    s_cbranch_vccnz L_pollE_l
    s_branch L_pollE_out
L_pollH:
    s_mov_b32 s97, 0
L_pollH_l:
    s_sleep 1
    s_mov_b64 exec, 0xff
    buffer_load_dword v13, v12, s[44:47], s73 offen sc1
    s_mov_b64 exec, -1
    s_add_u32 s97, s97, 1
    s_cmp_gt_u32 s97, 200000
    s_waitcnt vmcnt(0)
    s_cbranch_scc1 L_pollH_out
    v_cmp_ne_u32 vcc, s71, v13
    s_nop 1
    s_and_b64 vcc, vcc, 0xff
    s_cbranch_scc1 L_pollH_l
    s_branch L_pollH_out
L_spinM:
    s_mov_b32 s97, 0
L_spinM_l:
    s_sleep 1
    ds_read_b32 v16, v12 offset:0
    s_add_u32 s97, s97, 1
    s_cmp_gt_u32 s97, 4000000
    s_waitcnt lgkmcnt(0)
    s_cbranch_scc1 L_spinM_out
    v_cmp_ne_u32 vcc, 4, v16
    s_nop 1
    s_cbranch_vccnz L_spinM_l
    s_branch L_spinM_out
L_end:
    s_endpgm
.section .rodata,"a"
.p2align 6
.amdhsa_kernel gated_mix__ssm_conv_s5__swiglu_ffn__prompt_kernel
  .amdhsa_next_free_vgpr 256
  .amdhsa_next_free_sgpr 102
  .amdhsa_accum_offset 256
  .amdhsa_group_segment_fixed_size 0
  .amdhsa_kernarg_size 136
  .amdhsa_user_sgpr_count 2
  .amdhsa_user_sgpr_kernarg_segment_ptr 1
  .amdhsa_system_sgpr_workgroup_id_x 1
  .amdhsa_float_denorm_mode_32 3
.end_amdhsa_kernel
```
